```python
import torch

def _softmax(x, axis=-1):
    return torch.softmax(x, dim=axis)
def _gelu(x):
    return torch.nn.functional.gelu(x, approximate="tanh")
def _silu(x):
    return torch.nn.functional.silu(x)
def _sigmoid(x):
    return torch.sigmoid(x)
def _layernorm(x, axis=-1, eps=1e-5):
    m = x.mean(dim=axis, keepdim=True)
    v = x.var(dim=axis, keepdim=True, unbiased=False)
    return (x - m) / torch.sqrt(v + eps)
def _scatter_add(tgt, idx, src, axis=0):
    return tgt.clone().index_add_(axis, idx, src)
def _segment_sum(src, seg, n):
    out = torch.zeros((n,) + src.shape[1:], dtype=src.dtype)
    return out.index_add_(0, seg, src)
def _pad(x, pw):
    flat = tuple(v for pair in reversed(pw) for v in pair)
    return torch.nn.functional.pad(x, flat)

kernel_name = 'gated_mix__sliding_block__mixer_s_mlp__prompt'

def setup_inputs():

    _w = (lambda a: (lambda t: t.to(torch.bfloat16) if t.is_floating_point() else t)(torch.as_tensor(a)))
    def _A_setup():
        B, S, D = 1, 2048, 512
        return {
            "x": _w((lambda *s: torch.randn(*s, dtype=torch.bfloat16) * 0.05)(B, S, D)),
            "wqkv": _w((lambda *s: torch.randn(*s, dtype=torch.bfloat16) * 1.6)(D, 3 * D)),
            "wo": _w((lambda *s: torch.randn(*s, dtype=torch.bfloat16) * 0.4)(D, D)),
        }
    _A_in = _A_setup()

    def _B_setup():
        B, S, D, F = 1, 2048, 512, 1376
        return {
            "x":  _w((lambda *s: torch.randn(*s, dtype=torch.bfloat16) * 0.05)(B, S, D)),
            "w1": _w((lambda *s: torch.randn(*s, dtype=torch.bfloat16) * 3.2)(D, D) * (D ** -0.5)),
            "w2": _w((lambda *s: torch.randn(*s, dtype=torch.bfloat16) * 3.2)(D, D) * (D ** -0.5)),
            "w3": _w((lambda *s: torch.randn(*s, dtype=torch.bfloat16) * 3.2)(D, F) * (D ** -0.5)),
            "w4": _w((lambda *s: torch.randn(*s, dtype=torch.bfloat16) * 3.2)(F, D) * (F ** -0.5)),
        }
    _B_in = _B_setup()

    return {
        "A_x": _A_in["x"],
        "A_wqkv": _A_in["wqkv"],
        "A_wo": _A_in["wo"],
        "B_x": _B_in["x"],
        "B_w1": _B_in["w1"],
        "B_w2": _B_in["w2"],
        "B_w3": _B_in["w3"],
        "B_w4": _B_in["w4"],
        "gate_w": _w((lambda *s: torch.randn(*s, dtype=torch.bfloat16) * 0.05)(512) * 16.0),
    }

def reference(A_x, A_wqkv, A_wo, B_x, B_w1, B_w2, B_w3, B_w4, gate_w):
    def _A_ref(x, wqkv, wo):
        B, S, D = x.shape
        H = 32; Dh = D // H; W = 256
        qkv = (lambda x, *d: x.permute(*d))((x @ wqkv).reshape(B, S, 3, H, Dh), 2, 0, 3, 1, 4)
        q, k, v = qkv[0], qkv[1], qkv[2]
        scores = torch.einsum("bhqd,bhkd->bhqk", q, k) * (Dh ** -0.5)
        idx = torch.arange(S)
        mask = (idx[:, None] - idx[None, :] >= 0) & (idx[:, None] - idx[None, :] < W)
        scores = torch.where(mask[None, None], scores, -1e9)
        p = _softmax(scores, axis=-1)
        o = torch.einsum("bhqk,bhkd->bhqd", p, v)
        return (lambda x, *d: x.permute(*d))(o, 0, 2, 1, 3).reshape(B, S, D) @ wo

    def _B_ref(x, w1, w2, w3, w4):
        B, S, D = x.shape
        h = _gelu(_layernorm(x, axis=-1) @ w1)
        c = D // 4
        g0 = _pad(h[:, :, 0*c:1*c], ((0, 0), (1, 0), (0, 0)))[:, :S, :]
        g1 = _pad(h[:, :, 1*c:2*c], ((0, 0), (0, 1), (0, 0)))[:, 1:, :]
        g2 = _pad(h[:, :, 2*c:3*c], ((0, 0), (2, 0), (0, 0)))[:, :S, :]
        g3 = _pad(h[:, :, 3*c:   ], ((0, 0), (0, 2), (0, 0)))[:, 2:, :]
        hs = torch.concatenate([g0, g1, g2, g3], axis=-1) @ w2
        x1 = x + hs
        h2 = _gelu(_layernorm(x1, axis=-1) @ w3) @ w4
        return x1 + h2

    x = A_x
    g = _sigmoid((x * gate_w).sum(-1, keepdims=True))
    a = _A_ref(x, A_wqkv, A_wo)
    b = _B_ref(x, B_w1, B_w2, B_w3, B_w4)
    return g * a + (1 - g) * b
```

```asm
; @launch grid=(256,1,1) block=(512,1,1) lds=163840
.amdgcn_target "amdgcn-amd-amdhsa--gfx950"
.text
.globl gated_mix__sliding_block__mixer_s_mlp__prompt_kernel
.p2align 8
.type gated_mix__sliding_block__mixer_s_mlp__prompt_kernel,@function
gated_mix__sliding_block__mixer_s_mlp__prompt_kernel:
    s_cmp_ge_u32 s2, 256
    s_cbranch_scc1 L_end
    s_load_dwordx16 s[4:19], s[0:1], 0
    s_load_dwordx8 s[20:27], s[0:1], 64
    v_and_b32 v1, 63, v0
    v_lshrrev_b32 v5, 6, v0
    v_lshlrev_b32 v2, 4, v1
    v_readfirstlane_b32 s55, v5
    v_and_b32 v3, 31, v1
    v_lshrrev_b32 v4, 5, v1
    s_and_b32 s50, s2, 7
    s_lshr_b32 s51, s2, 3
    s_getpc_b64 s[52:53]
    s_lshl_b32 s54, s51, 3
    s_add_u32 s54, s54, s55
    s_lshl_b32 s54, s54, 8
    v_lshlrev_b32 v6, 7, v4
    v_add_u32 v6, s54, v6
    v_min_u32 v6, CODE_BYTES, v6
    global_load_dword v254, v6, s[52:53]
    s_and_b32 s44, s55, 3
    s_and_b32 s45, s44, 1
    s_lshr_b32 s46, s44, 1
    s_lshr_b32 s47, s51, 3
    s_lshl_b32 s52, s50, 2
    s_add_u32 s47, s47, s52
    s_and_b32 s48, s51, 7
    s_lshl_b32 s49, s47, 1
    s_add_u32 s49, s49, s45
    s_and_b32 s96, s51, 15
    s_lshr_b32 s97, s47, 1
    s_mov_b32 s3, 0
    s_and_b32 s52, s96, 7
    s_lshl_b32 s52, s52, 7
    s_cmp_lt_u32 s96, 8
    s_cselect_b32 s63, 1, 3
    s_cselect_b32 s53, 0, 1
    s_lshl_b32 s63, s63, 10
    s_lshl_b32 s53, s53, 10
    s_add_u32 s61, s52, s53
    s_add_u32 s62, s61, s53
    s_xor_b32 s61, s61, 128
    s_xor_b32 s62, s62, 512
    s_mul_i32 s52, s44, 49152
    s_add_u32 s61, s61, s52
    v_lshrrev_b32 v5, 4, v1
    v_xor_b32 v5, v5, v1
    v_and_b32 v5, 7, v5
    v_lshlrev_b32 v5, 4, v5
    v_lshrrev_b32 v12, 3, v1
    v_lshl_add_u32 v8, v12, 10, v5
    v_xor_b32 v9, 64, v8
    v_add_u32 v9, 8192, v9
    v_and_b32 v5, 2, v12
    v_lshlrev_b32 v5, 1, v5
    v_xor_b32 v5, v5, v1
    v_and_b32 v5, 7, v5
    v_lshlrev_b32 v5, 4, v5
    v_mul_u32_u24 v10, 3072, v12
    v_add_u32 v10, v10, v5
    v_mul_u32_u24 v11, s63, v12
    v_add_u32 v11, v11, v5
    s_lshl_b32 s63, s63, 3
    s_mul_i32 s52, s63, s44
    s_lshl_b32 s52, s52, 1
    s_add_u32 s62, s62, s52
    s_mul_i32 s64, s63, 7
    s_lshl_b32 s60, s97, 17
    s_lshl_b32 s52, s44, 15
    s_add_u32 s60, s60, s52
    s_add_u32 s66, s60, 16384
    s_lshl_b32 s59, s44, 12
    s_lshl_b32 s68, s44, 11
    s_waitcnt lgkmcnt(0)
    s_lshr_b32 s2, s55, 2
    s_cmp_eq_u32 s2, 0
    s_cbranch_scc1 L_G0
    s_mov_b64 s[36:37], s[4:5]
    s_mov_b32 s38, 2097152
    s_mov_b32 s39, 0x20000
    s_mov_b64 s[32:33], s[6:7]
    s_mov_b32 s34, 1572864
    s_mov_b32 s35, 0x20000
    s_add_u32 m0, s59, 0
    s_nop 0
    buffer_load_dwordx4 v8, s[36:39], s60 offen lds
    s_add_u32 m0, s68, 16384
    s_nop 0
    buffer_load_dwordx4 v10, s[32:35], s61 offen lds
    s_add_u32 s61, s61, 24576
    s_add_u32 m0, s59, 1024
    s_nop 0
    buffer_load_dwordx4 v9, s[36:39], s60 offen lds
    s_add_u32 s60, s60, 128
    s_add_u32 m0, s59, 2048
    s_nop 0
    buffer_load_dwordx4 v8, s[36:39], s66 offen lds
    s_add_u32 m0, s68, 17408
    s_nop 0
    buffer_load_dwordx4 v10, s[32:35], s61 offen lds
    s_add_u32 s61, s61, 172032
    s_add_u32 m0, s59, 3072
    s_nop 0
    buffer_load_dwordx4 v9, s[36:39], s66 offen lds
    s_add_u32 s66, s66, 128
    s_add_u32 m0, s59, 24576
    s_nop 0
    buffer_load_dwordx4 v8, s[36:39], s60 offen lds
    s_add_u32 m0, s68, 40960
    s_nop 0
    buffer_load_dwordx4 v10, s[32:35], s61 offen lds
    s_add_u32 s61, s61, 24576
    s_add_u32 m0, s59, 25600
    s_nop 0
    buffer_load_dwordx4 v9, s[36:39], s60 offen lds
    s_add_u32 s60, s60, 128
    s_add_u32 m0, s59, 26624
    s_nop 0
    buffer_load_dwordx4 v8, s[36:39], s66 offen lds
    s_add_u32 m0, s68, 41984
    s_nop 0
    buffer_load_dwordx4 v10, s[32:35], s61 offen lds
    s_add_u32 s61, s61, 172032
    s_add_u32 m0, s59, 27648
    s_nop 0
    buffer_load_dwordx4 v9, s[36:39], s66 offen lds
    s_add_u32 s66, s66, 128
    s_cmp_lt_u32 s96, 8
    s_cselect_b64 s[40:41], s[12:13], s[6:7]
    s_lshl_b32 s42, s63, 6
    s_mov_b32 s43, 0x20000
    s_mov_b64 s[28:29], s[26:27]
    s_mov_b32 s30, 21233664
    s_mov_b32 s31, 0x20000
    v_lshrrev_b32 v5, 3, v1
    v_and_b32 v6, 2, v5
    v_lshlrev_b32 v6, 1, v6
    v_xor_b32 v6, v6, v1
    v_and_b32 v6, 7, v6
    v_lshlrev_b32 v6, 4, v6
    v_mul_u32_u24 v5, 1024, v5
    v_add_u32 v6, v6, v5
    s_lshl_b32 s58, s48, 7
    s_lshl_b32 s52, s44, 13
    s_add_u32 s58, s58, s52
    s_lshl_b32 s67, s44, 10
    s_lshl_b32 s52, s51, 6
    s_lshl_b32 s53, s50, 3
    s_add_u32 s52, s52, s53
    s_lshl_b32 s53, s44, 2
    s_add_u32 s52, s52, s53
    s_lshl_b32 s52, s52, 10
    s_add_u32 s52, s52, 2088960
    s_or_b32 s53, s46, s50
    s_cmp_eq_u32 s53, 0
    s_cselect_b32 s74, 0x40000000, s52
    s_add_u32 s75, s74, 2097152
    s_lshl_b32 s52, s50, 3
    s_lshl_b32 s53, s44, 2
    s_add_u32 s53, s53, s52
    s_sub_u32 s53, s53, 8
    v_and_b32 v5, 3, v1
    v_add_u32 v13, s53, v5
    v_max_i32 v13, 0, v13
    s_lshr_b32 s54, s51, 2
    s_lshl_b32 s54, s54, 2
    v_lshlrev_b32 v13, 7, v13
    v_add_u32 v37, s54, v13
    v_add_u32 v37, 64, v37
    s_add_u32 s52, s52, s44
    v_and_b32 v5, 1, v1
    v_lshlrev_b32 v5, 2, v5
    v_add_u32 v38, s52, v5
    v_lshlrev_b32 v38, 7, v38
    v_add_u32 v38, s54, v38
    v_lshrrev_b32 v5, 10, v38
    v_cmp_eq_u32 vcc, s50, v5
    v_add_u32 v5, 20865024, v38
    v_lshlrev_b32 v15, 5, v38
    v_add_u32 v15, 20971520, v15
    v_cndmask_b32 v12, v15, v5, vcc
    v_cmp_gt_u32 vcc, 4, v1
    s_nop 1
    v_cndmask_b32 v38, v38, v37, vcc
    v_lshrrev_b32 v5, 10, v38
    v_cmp_eq_u32 vcc, s50, v5
    v_add_u32 v5, 20865024, v38
    v_lshlrev_b32 v19, 5, v38
    v_add_u32 v19, 20971520, v19
    v_cndmask_b32 v18, v19, v5, vcc
    v_add_u32 v37, 32, v37
    v_lshrrev_b32 v5, 10, v37
    v_cmp_eq_u32 vcc, s50, v5
    v_add_u32 v5, 20865024, v37
    v_lshlrev_b32 v13, 5, v37
    v_add_u32 v13, 20971520, v13
    v_cndmask_b32 v14, v13, v5, vcc
    v_mov_b32 v52, 0x3f803f80
    v_mov_b32 v53, 0x3f803f80
    v_mov_b64 v[54:55], v[52:53]
    v_mov_b64 v[56:57], v[52:53]
    v_mov_b64 v[58:59], v[52:53]
    v_mov_b64 v[60:61], v[52:53]
    v_mov_b64 v[62:63], v[52:53]
    v_mov_b64 v[64:65], v[52:53]
    v_mov_b64 v[66:67], v[52:53]
    v_mov_b64 v[68:69], v[52:53]
    v_mov_b64 v[70:71], v[52:53]
    v_mov_b64 v[72:73], v[52:53]
    v_mov_b64 v[74:75], v[52:53]
    v_mov_b64 v[76:77], v[52:53]
    v_mov_b64 v[78:79], v[52:53]
    v_mov_b64 v[80:81], v[52:53]
    v_mov_b64 v[82:83], v[52:53]
    v_mov_b64 v[84:85], v[52:53]
    v_mov_b64 v[86:87], v[52:53]
    v_mov_b64 v[88:89], v[52:53]
    v_mov_b64 v[90:91], v[52:53]
    v_mov_b64 v[92:93], v[52:53]
    v_mov_b64 v[94:95], v[52:53]
    v_mov_b64 v[96:97], v[52:53]
    v_mov_b64 v[98:99], v[52:53]
    v_mov_b64 v[100:101], v[52:53]
    v_mov_b64 v[102:103], v[52:53]
    v_mov_b64 v[104:105], v[52:53]
    v_mov_b64 v[106:107], v[52:53]
    v_mov_b64 v[108:109], v[52:53]
    v_mov_b64 v[110:111], v[52:53]
    v_mov_b64 v[112:113], v[52:53]
    v_mov_b64 v[114:115], v[52:53]
    v_mov_b64 v[116:117], v[52:53]
    v_mov_b64 v[118:119], v[52:53]
    v_mov_b64 v[120:121], v[52:53]
    v_mov_b64 v[122:123], v[52:53]
    v_bfe_u32 v5, v1, 2, 2
    v_lshlrev_b32 v16, 3, v4
    v_add_u32 v16, v16, v5
    v_lshlrev_b32 v16, 7, v16
    v_lshrrev_b32 v5, 1, v5
    v_lshl_add_u32 v16, v5, 6, v16
    v_bfe_u32 v5, v1, 4, 1
    v_lshl_add_u32 v16, v5, 5, v16
    v_and_b32 v5, 3, v1
    v_lshl_add_u32 v16, v5, 3, v16
    s_add_u32 s52, s68, 94208
    v_add_u32 v16, s52, v16
    v_xor_b32 v17, 64, v16
    v_mov_b32 v20, 0
    v_mov_b32 v21, 0
    v_mov_b32 v22, 0
    v_mov_b32 v23, 0
    s_waitcnt vmcnt(6)
    s_barrier
    s_add_u32 m0, s59, 49152
    s_nop 0
    buffer_load_dwordx4 v8, s[36:39], s60 offen lds
    s_add_u32 m0, s68, 65536
    s_nop 0
    buffer_load_dwordx4 v10, s[32:35], s61 offen lds
    s_add_u32 s61, s61, 24576
    s_add_u32 m0, s59, 50176
    s_nop 0
    buffer_load_dwordx4 v9, s[36:39], s60 offen lds
    s_add_u32 s60, s60, 128
    s_add_u32 m0, s59, 51200
    s_nop 0
    buffer_load_dwordx4 v8, s[36:39], s66 offen lds
    s_add_u32 m0, s68, 66560
    s_nop 0
    buffer_load_dwordx4 v10, s[32:35], s61 offen lds
    s_add_u32 s61, s61, 172032
    s_add_u32 m0, s59, 52224
    s_nop 0
    buffer_load_dwordx4 v9, s[36:39], s66 offen lds
    s_add_u32 s66, s66, 128
    s_add_u32 m0, s68, 94208
    s_nop 0
    buffer_load_dwordx4 v11, s[40:43], s62 offen lds
    s_add_u32 s62, s62, s63
    s_add_u32 m0, s68, 95232
    s_nop 0
    buffer_load_dwordx4 v11, s[40:43], s62 offen lds
    s_add_u32 s62, s62, s64
    s_waitcnt vmcnt(8)
    s_barrier
    s_add_u32 m0, s59, 0
    s_nop 0
    buffer_load_dwordx4 v8, s[36:39], s60 offen lds
    s_add_u32 m0, s68, 16384
    s_nop 0
    buffer_load_dwordx4 v10, s[32:35], s61 offen lds
    s_add_u32 s61, s61, 24576
    s_add_u32 m0, s59, 1024
    s_nop 0
    buffer_load_dwordx4 v9, s[36:39], s60 offen lds
    s_add_u32 s60, s60, 128
    s_add_u32 m0, s59, 2048
    s_nop 0
    buffer_load_dwordx4 v8, s[36:39], s66 offen lds
    s_add_u32 m0, s68, 17408
    s_nop 0
    buffer_load_dwordx4 v10, s[32:35], s61 offen lds
    s_add_u32 s61, s61, 172032
    s_add_u32 m0, s59, 3072
    s_nop 0
    buffer_load_dwordx4 v9, s[36:39], s66 offen lds
    s_add_u32 s66, s66, 128
    s_add_u32 m0, s68, 102400
    s_nop 0
    buffer_load_dwordx4 v11, s[40:43], s62 offen lds
    s_add_u32 s62, s62, s63
    s_add_u32 m0, s68, 103424
    s_nop 0
    buffer_load_dwordx4 v11, s[40:43], s62 offen lds
    s_add_u32 s62, s62, s64
    s_waitcnt vmcnt(10)
    s_barrier
    s_add_u32 m0, s59, 24576
    s_nop 0
    buffer_load_dwordx4 v8, s[36:39], s60 offen lds
    s_add_u32 m0, s68, 40960
    s_nop 0
    buffer_load_dwordx4 v10, s[32:35], s61 offen lds
    s_add_u32 s61, s61, 24576
    s_add_u32 m0, s59, 25600
    s_nop 0
    buffer_load_dwordx4 v9, s[36:39], s60 offen lds
    s_add_u32 s60, s60, 128
    s_add_u32 m0, s59, 26624
    s_nop 0
    buffer_load_dwordx4 v8, s[36:39], s66 offen lds
    s_add_u32 m0, s68, 41984
    s_nop 0
    buffer_load_dwordx4 v10, s[32:35], s61 offen lds
    s_add_u32 s61, s61, 172032
    s_add_u32 m0, s59, 27648
    s_nop 0
    buffer_load_dwordx4 v9, s[36:39], s66 offen lds
    s_add_u32 s66, s66, 128
    s_add_u32 m0, s68, 110592
    s_nop 0
    buffer_load_dwordx4 v11, s[40:43], s62 offen lds
    s_add_u32 s62, s62, s63
    s_add_u32 m0, s68, 111616
    s_nop 0
    buffer_load_dwordx4 v11, s[40:43], s62 offen lds
    s_add_u32 s62, s62, s64
    s_waitcnt vmcnt(10)
    s_barrier
    s_add_u32 m0, s59, 49152
    s_nop 0
    buffer_load_dwordx4 v8, s[36:39], s60 offen lds
    s_add_u32 m0, s68, 65536
    s_nop 0
    buffer_load_dwordx4 v10, s[32:35], s61 offen lds
    s_add_u32 s61, s61, 24576
    s_add_u32 m0, s59, 50176
    s_nop 0
    buffer_load_dwordx4 v9, s[36:39], s60 offen lds
    s_add_u32 s60, s60, 128
    s_add_u32 m0, s59, 51200
    s_nop 0
    buffer_load_dwordx4 v8, s[36:39], s66 offen lds
    s_add_u32 m0, s68, 66560
    s_nop 0
    buffer_load_dwordx4 v10, s[32:35], s61 offen lds
    s_add_u32 s61, s61, 172032
    s_add_u32 m0, s59, 52224
    s_nop 0
    buffer_load_dwordx4 v9, s[36:39], s66 offen lds
    s_add_u32 s66, s66, 128
    s_add_u32 m0, s68, 118784
    s_nop 0
    buffer_load_dwordx4 v11, s[40:43], s62 offen lds
    s_add_u32 s62, s62, s63
    s_add_u32 m0, s68, 119808
    s_nop 0
    buffer_load_dwordx4 v11, s[40:43], s62 offen lds
    s_add_u32 s62, s62, s64
    s_cmp_ge_u32 s96, 8
    s_cbranch_scc1 nocs1_1
    ds_read_b64_tr_b16 v[160:161], v16 offset:0
    ds_read_b64_tr_b16 v[162:163], v16 offset:512
    ds_read_b64_tr_b16 v[164:165], v17 offset:0
    ds_read_b64_tr_b16 v[166:167], v17 offset:512
    s_waitcnt lgkmcnt(0)
    v_lshlrev_b32 v24, 16, v160
    v_and_b32 v25, 0xffff0000, v160
    v_lshlrev_b32 v26, 16, v161
    v_and_b32 v27, 0xffff0000, v161
    v_lshlrev_b32 v28, 16, v162
    v_and_b32 v29, 0xffff0000, v162
    v_lshlrev_b32 v30, 16, v163
    v_and_b32 v31, 0xffff0000, v163
    v_add_f32 v20, v20, v24
    v_add_f32 v21, v21, v25
    v_add_f32 v20, v20, v26
    v_add_f32 v21, v21, v27
    v_add_f32 v20, v20, v28
    v_add_f32 v21, v21, v29
    v_add_f32 v20, v20, v30
    v_add_f32 v21, v21, v31
    v_lshlrev_b32 v24, 16, v164
    v_and_b32 v25, 0xffff0000, v164
    v_lshlrev_b32 v26, 16, v165
    v_and_b32 v27, 0xffff0000, v165
    v_lshlrev_b32 v28, 16, v166
    v_and_b32 v29, 0xffff0000, v166
    v_lshlrev_b32 v30, 16, v167
    v_and_b32 v31, 0xffff0000, v167
    v_add_f32 v22, v22, v24
    v_add_f32 v23, v23, v25
    v_add_f32 v22, v22, v26
    v_add_f32 v23, v23, v27
    v_add_f32 v22, v22, v28
    v_add_f32 v23, v23, v29
    v_add_f32 v22, v22, v30
    v_add_f32 v23, v23, v31
nocs1_1:
    s_waitcnt vmcnt(10)
    s_barrier
    s_add_u32 m0, s59, 0
    s_nop 0
    buffer_load_dwordx4 v8, s[36:39], s60 offen lds
    s_add_u32 m0, s68, 16384
    s_nop 0
    buffer_load_dwordx4 v10, s[32:35], s61 offen lds
    s_add_u32 s61, s61, 24576
    s_add_u32 m0, s59, 1024
    s_nop 0
    buffer_load_dwordx4 v9, s[36:39], s60 offen lds
    s_add_u32 s60, s60, 128
    s_add_u32 m0, s59, 2048
    s_nop 0
    buffer_load_dwordx4 v8, s[36:39], s66 offen lds
    s_add_u32 m0, s68, 17408
    s_nop 0
    buffer_load_dwordx4 v10, s[32:35], s61 offen lds
    s_add_u32 s61, s61, 172032
    s_add_u32 m0, s59, 3072
    s_nop 0
    buffer_load_dwordx4 v9, s[36:39], s66 offen lds
    s_add_u32 s66, s66, 128
    s_add_u32 m0, s68, 126976
    s_nop 0
    buffer_load_dwordx4 v11, s[40:43], s62 offen lds
    s_add_u32 s62, s62, s63
    s_add_u32 m0, s68, 128000
    s_nop 0
    buffer_load_dwordx4 v11, s[40:43], s62 offen lds
    s_add_u32 s62, s62, s64
    s_cmp_ge_u32 s96, 8
    s_cbranch_scc1 nocs1_2
    ds_read_b64_tr_b16 v[168:169], v16 offset:8192
    ds_read_b64_tr_b16 v[170:171], v16 offset:8704
    ds_read_b64_tr_b16 v[172:173], v17 offset:8192
    ds_read_b64_tr_b16 v[174:175], v17 offset:8704
    s_waitcnt lgkmcnt(0)
    v_lshlrev_b32 v24, 16, v168
    v_and_b32 v25, 0xffff0000, v168
    v_lshlrev_b32 v26, 16, v169
    v_and_b32 v27, 0xffff0000, v169
    v_lshlrev_b32 v28, 16, v170
    v_and_b32 v29, 0xffff0000, v170
    v_lshlrev_b32 v30, 16, v171
    v_and_b32 v31, 0xffff0000, v171
    v_add_f32 v20, v20, v24
    v_add_f32 v21, v21, v25
    v_add_f32 v20, v20, v26
    v_add_f32 v21, v21, v27
    v_add_f32 v20, v20, v28
    v_add_f32 v21, v21, v29
    v_add_f32 v20, v20, v30
    v_add_f32 v21, v21, v31
    v_lshlrev_b32 v24, 16, v172
    v_and_b32 v25, 0xffff0000, v172
    v_lshlrev_b32 v26, 16, v173
    v_and_b32 v27, 0xffff0000, v173
    v_lshlrev_b32 v28, 16, v174
    v_and_b32 v29, 0xffff0000, v174
    v_lshlrev_b32 v30, 16, v175
    v_and_b32 v31, 0xffff0000, v175
    v_add_f32 v22, v22, v24
    v_add_f32 v23, v23, v25
    v_add_f32 v22, v22, v26
    v_add_f32 v23, v23, v27
    v_add_f32 v22, v22, v28
    v_add_f32 v23, v23, v29
    v_add_f32 v22, v22, v30
    v_add_f32 v23, v23, v31
nocs1_2:
    s_waitcnt vmcnt(10)
    s_barrier
    s_add_u32 m0, s59, 24576
    s_nop 0
    buffer_load_dwordx4 v8, s[36:39], s60 offen lds
    s_add_u32 m0, s68, 40960
    s_nop 0
    buffer_load_dwordx4 v10, s[32:35], s61 offen lds
    s_add_u32 s61, s61, 24576
    s_add_u32 m0, s59, 25600
    s_nop 0
    buffer_load_dwordx4 v9, s[36:39], s60 offen lds
    s_add_u32 s60, s60, 128
    s_add_u32 m0, s59, 26624
    s_nop 0
    buffer_load_dwordx4 v8, s[36:39], s66 offen lds
    s_add_u32 m0, s68, 41984
    s_nop 0
    buffer_load_dwordx4 v10, s[32:35], s61 offen lds
    s_add_u32 s61, s61, 172032
    s_add_u32 m0, s59, 27648
    s_nop 0
    buffer_load_dwordx4 v9, s[36:39], s66 offen lds
    s_add_u32 s66, s66, 128
    s_add_u32 m0, s68, 135168
    s_nop 0
    buffer_load_dwordx4 v11, s[40:43], s62 offen lds
    s_add_u32 s62, s62, s63
    s_add_u32 m0, s68, 136192
    s_nop 0
    buffer_load_dwordx4 v11, s[40:43], s62 offen lds
    s_add_u32 s62, s62, s64
    s_cmp_ge_u32 s96, 8
    s_cbranch_scc1 nocs1_3
    ds_read_b64_tr_b16 v[176:177], v16 offset:16384
    ds_read_b64_tr_b16 v[178:179], v16 offset:16896
    ds_read_b64_tr_b16 v[180:181], v17 offset:16384
    ds_read_b64_tr_b16 v[182:183], v17 offset:16896
    s_waitcnt lgkmcnt(0)
    v_lshlrev_b32 v24, 16, v176
    v_and_b32 v25, 0xffff0000, v176
    v_lshlrev_b32 v26, 16, v177
    v_and_b32 v27, 0xffff0000, v177
    v_lshlrev_b32 v28, 16, v178
    v_and_b32 v29, 0xffff0000, v178
    v_lshlrev_b32 v30, 16, v179
    v_and_b32 v31, 0xffff0000, v179
    v_add_f32 v20, v20, v24
    v_add_f32 v21, v21, v25
    v_add_f32 v20, v20, v26
    v_add_f32 v21, v21, v27
    v_add_f32 v20, v20, v28
    v_add_f32 v21, v21, v29
    v_add_f32 v20, v20, v30
    v_add_f32 v21, v21, v31
    v_lshlrev_b32 v24, 16, v180
    v_and_b32 v25, 0xffff0000, v180
    v_lshlrev_b32 v26, 16, v181
    v_and_b32 v27, 0xffff0000, v181
    v_lshlrev_b32 v28, 16, v182
    v_and_b32 v29, 0xffff0000, v182
    v_lshlrev_b32 v30, 16, v183
    v_and_b32 v31, 0xffff0000, v183
    v_add_f32 v22, v22, v24
    v_add_f32 v23, v23, v25
    v_add_f32 v22, v22, v26
    v_add_f32 v23, v23, v27
    v_add_f32 v22, v22, v28
    v_add_f32 v23, v23, v29
    v_add_f32 v22, v22, v30
    v_add_f32 v23, v23, v31
nocs1_3:
    s_waitcnt vmcnt(10)
    s_barrier
    s_add_u32 m0, s68, 143360
    s_nop 0
    buffer_load_dwordx4 v11, s[40:43], s62 offen lds
    s_add_u32 s62, s62, s63
    s_add_u32 m0, s68, 144384
    s_nop 0
    buffer_load_dwordx4 v11, s[40:43], s62 offen lds
    s_add_u32 s62, s62, s64
    s_add_u32 m0, s68, 151552
    s_nop 0
    buffer_load_dwordx4 v11, s[40:43], s62 offen lds
    s_add_u32 s62, s62, s63
    s_add_u32 m0, s68, 152576
    s_nop 0
    buffer_load_dwordx4 v11, s[40:43], s62 offen lds
    s_add_u32 s62, s62, s64
    s_cmp_ge_u32 s96, 8
    s_cbranch_scc1 nocs1_4
    ds_read_b64_tr_b16 v[184:185], v16 offset:24576
    ds_read_b64_tr_b16 v[186:187], v16 offset:25088
    ds_read_b64_tr_b16 v[188:189], v17 offset:24576
    ds_read_b64_tr_b16 v[190:191], v17 offset:25088
    s_waitcnt lgkmcnt(0)
    v_lshlrev_b32 v24, 16, v184
    v_and_b32 v25, 0xffff0000, v184
    v_lshlrev_b32 v26, 16, v185
    v_and_b32 v27, 0xffff0000, v185
    v_lshlrev_b32 v28, 16, v186
    v_and_b32 v29, 0xffff0000, v186
    v_lshlrev_b32 v30, 16, v187
    v_and_b32 v31, 0xffff0000, v187
    v_add_f32 v20, v20, v24
    v_add_f32 v21, v21, v25
    v_add_f32 v20, v20, v26
    v_add_f32 v21, v21, v27
    v_add_f32 v20, v20, v28
    v_add_f32 v21, v21, v29
    v_add_f32 v20, v20, v30
    v_add_f32 v21, v21, v31
    v_lshlrev_b32 v24, 16, v188
    v_and_b32 v25, 0xffff0000, v188
    v_lshlrev_b32 v26, 16, v189
    v_and_b32 v27, 0xffff0000, v189
    v_lshlrev_b32 v28, 16, v190
    v_and_b32 v29, 0xffff0000, v190
    v_lshlrev_b32 v30, 16, v191
    v_and_b32 v31, 0xffff0000, v191
    v_add_f32 v22, v22, v24
    v_add_f32 v23, v23, v25
    v_add_f32 v22, v22, v26
    v_add_f32 v23, v23, v27
    v_add_f32 v22, v22, v28
    v_add_f32 v23, v23, v29
    v_add_f32 v22, v22, v30
    v_add_f32 v23, v23, v31
nocs1_4:
    s_waitcnt vmcnt(6)
    s_barrier
    s_cmp_ge_u32 s96, 8
    s_cbranch_scc1 nocs1_5
    ds_read_b64_tr_b16 v[192:193], v16 offset:32768
    ds_read_b64_tr_b16 v[194:195], v16 offset:33280
    ds_read_b64_tr_b16 v[196:197], v17 offset:32768
    ds_read_b64_tr_b16 v[198:199], v17 offset:33280
    s_waitcnt lgkmcnt(0)
    v_lshlrev_b32 v24, 16, v192
    v_and_b32 v25, 0xffff0000, v192
    v_lshlrev_b32 v26, 16, v193
    v_and_b32 v27, 0xffff0000, v193
    v_lshlrev_b32 v28, 16, v194
    v_and_b32 v29, 0xffff0000, v194
    v_lshlrev_b32 v30, 16, v195
    v_and_b32 v31, 0xffff0000, v195
    v_add_f32 v20, v20, v24
    v_add_f32 v21, v21, v25
    v_add_f32 v20, v20, v26
    v_add_f32 v21, v21, v27
    v_add_f32 v20, v20, v28
    v_add_f32 v21, v21, v29
    v_add_f32 v20, v20, v30
    v_add_f32 v21, v21, v31
    v_lshlrev_b32 v24, 16, v196
    v_and_b32 v25, 0xffff0000, v196
    v_lshlrev_b32 v26, 16, v197
    v_and_b32 v27, 0xffff0000, v197
    v_lshlrev_b32 v28, 16, v198
    v_and_b32 v29, 0xffff0000, v198
    v_lshlrev_b32 v30, 16, v199
    v_and_b32 v31, 0xffff0000, v199
    v_add_f32 v22, v22, v24
    v_add_f32 v23, v23, v25
    v_add_f32 v22, v22, v26
    v_add_f32 v23, v23, v27
    v_add_f32 v22, v22, v28
    v_add_f32 v23, v23, v29
    v_add_f32 v22, v22, v30
    v_add_f32 v23, v23, v31
nocs1_5:
    v_mov_b32 v36, 159872
    ds_read_b32 v36, v36
    s_mov_b64 s[40:41], s[14:15]
    s_mov_b32 s42, 524288
    s_waitcnt vmcnt(0) lgkmcnt(0)
    v_readfirstlane_b32 s3, v36
    s_barrier
    v_mov_b32 v36, 159876
    ds_read_b32 v36, v36
    s_add_u32 m0, s67, 28672
    s_add_u32 s52, s58, 0
    buffer_load_dwordx4 v6, s[40:43], s52 offen lds
    s_add_u32 m0, s67, 32768
    s_add_u32 s52, s58, 32768
    buffer_load_dwordx4 v6, s[40:43], s52 offen lds
    s_add_u32 m0, s67, 36864
    s_add_u32 s52, s58, 65536
    buffer_load_dwordx4 v6, s[40:43], s52 offen lds
    s_add_u32 m0, s67, 40960
    s_add_u32 s52, s58, 98304
    buffer_load_dwordx4 v6, s[40:43], s52 offen lds
    s_add_u32 m0, s67, 45056
    s_add_u32 s52, s58, 131072
    buffer_load_dwordx4 v6, s[40:43], s52 offen lds
    s_add_u32 m0, s67, 49152
    s_add_u32 s52, s58, 163840
    buffer_load_dwordx4 v6, s[40:43], s52 offen lds
    s_waitcnt lgkmcnt(0)
    v_readfirstlane_b32 s2, v36
    s_cmp_ge_u32 s96, 8
    s_cbranch_scc1 nocs1_6
    ds_read_b64_tr_b16 v[200:201], v16 offset:40960
    ds_read_b64_tr_b16 v[202:203], v16 offset:41472
    ds_read_b64_tr_b16 v[204:205], v17 offset:40960
    ds_read_b64_tr_b16 v[206:207], v17 offset:41472
    ds_read_b64_tr_b16 v[208:209], v16 offset:49152
    ds_read_b64_tr_b16 v[210:211], v16 offset:49664
    ds_read_b64_tr_b16 v[212:213], v17 offset:49152
    ds_read_b64_tr_b16 v[214:215], v17 offset:49664
    ds_read_b64_tr_b16 v[216:217], v16 offset:57344
    ds_read_b64_tr_b16 v[218:219], v16 offset:57856
    ds_read_b64_tr_b16 v[220:221], v17 offset:57344
    ds_read_b64_tr_b16 v[222:223], v17 offset:57856
    s_waitcnt lgkmcnt(8)
    v_lshlrev_b32 v24, 16, v200
    v_and_b32 v25, 0xffff0000, v200
    v_lshlrev_b32 v26, 16, v201
    v_and_b32 v27, 0xffff0000, v201
    v_lshlrev_b32 v28, 16, v202
    v_and_b32 v29, 0xffff0000, v202
    v_lshlrev_b32 v30, 16, v203
    v_and_b32 v31, 0xffff0000, v203
    v_add_f32 v20, v20, v24
    v_add_f32 v21, v21, v25
    v_add_f32 v20, v20, v26
    v_add_f32 v21, v21, v27
    v_add_f32 v20, v20, v28
    v_add_f32 v21, v21, v29
    v_add_f32 v20, v20, v30
    v_add_f32 v21, v21, v31
    v_lshlrev_b32 v24, 16, v204
    v_and_b32 v25, 0xffff0000, v204
    v_lshlrev_b32 v26, 16, v205
    v_and_b32 v27, 0xffff0000, v205
    v_lshlrev_b32 v28, 16, v206
    v_and_b32 v29, 0xffff0000, v206
    v_lshlrev_b32 v30, 16, v207
    v_and_b32 v31, 0xffff0000, v207
    v_add_f32 v22, v22, v24
    v_add_f32 v23, v23, v25
    v_add_f32 v22, v22, v26
    v_add_f32 v23, v23, v27
    v_add_f32 v22, v22, v28
    v_add_f32 v23, v23, v29
    v_add_f32 v22, v22, v30
    v_add_f32 v23, v23, v31
    s_waitcnt lgkmcnt(4)
    v_lshlrev_b32 v24, 16, v208
    v_and_b32 v25, 0xffff0000, v208
    v_lshlrev_b32 v26, 16, v209
    v_and_b32 v27, 0xffff0000, v209
    v_lshlrev_b32 v28, 16, v210
    v_and_b32 v29, 0xffff0000, v210
    v_lshlrev_b32 v30, 16, v211
    v_and_b32 v31, 0xffff0000, v211
    v_add_f32 v20, v20, v24
    v_add_f32 v21, v21, v25
    v_add_f32 v20, v20, v26
    v_add_f32 v21, v21, v27
    v_add_f32 v20, v20, v28
    v_add_f32 v21, v21, v29
    v_add_f32 v20, v20, v30
    v_add_f32 v21, v21, v31
    v_lshlrev_b32 v24, 16, v212
    v_and_b32 v25, 0xffff0000, v212
    v_lshlrev_b32 v26, 16, v213
    v_and_b32 v27, 0xffff0000, v213
    v_lshlrev_b32 v28, 16, v214
    v_and_b32 v29, 0xffff0000, v214
    v_lshlrev_b32 v30, 16, v215
    v_and_b32 v31, 0xffff0000, v215
    v_add_f32 v22, v22, v24
    v_add_f32 v23, v23, v25
    v_add_f32 v22, v22, v26
    v_add_f32 v23, v23, v27
    v_add_f32 v22, v22, v28
    v_add_f32 v23, v23, v29
    v_add_f32 v22, v22, v30
    v_add_f32 v23, v23, v31
    s_waitcnt lgkmcnt(0)
    v_lshlrev_b32 v24, 16, v216
    v_and_b32 v25, 0xffff0000, v216
    v_lshlrev_b32 v26, 16, v217
    v_and_b32 v27, 0xffff0000, v217
    v_lshlrev_b32 v28, 16, v218
    v_and_b32 v29, 0xffff0000, v218
    v_lshlrev_b32 v30, 16, v219
    v_and_b32 v31, 0xffff0000, v219
    v_add_f32 v20, v20, v24
    v_add_f32 v21, v21, v25
    v_add_f32 v20, v20, v26
    v_add_f32 v21, v21, v27
    v_add_f32 v20, v20, v28
    v_add_f32 v21, v21, v29
    v_add_f32 v20, v20, v30
    v_add_f32 v21, v21, v31
    v_lshlrev_b32 v24, 16, v220
    v_and_b32 v25, 0xffff0000, v220
    v_lshlrev_b32 v26, 16, v221
    v_and_b32 v27, 0xffff0000, v221
    v_lshlrev_b32 v28, 16, v222
    v_and_b32 v29, 0xffff0000, v222
    v_lshlrev_b32 v30, 16, v223
    v_and_b32 v31, 0xffff0000, v223
    v_add_f32 v22, v22, v24
    v_add_f32 v23, v23, v25
    v_add_f32 v22, v22, v26
    v_add_f32 v23, v23, v27
    v_add_f32 v22, v22, v28
    v_add_f32 v23, v23, v29
    v_add_f32 v22, v22, v30
    v_add_f32 v23, v23, v31
    v_add_f32 v20, v20, v21
    v_add_f32 v22, v22, v23
    v_mov_b32 v24, v20
    s_nop 1
    v_permlane32_swap_b32 v20, v24
    v_add_f32 v20, v20, v24
    v_mov_b32 v25, v22
    s_nop 1
    v_permlane32_swap_b32 v22, v25
    v_add_f32 v22, v22, v25
    s_lshl_b32 s52, s44, 8
    v_lshlrev_b32 v5, 2, v3
    v_add_u32 v5, s52, v5
    v_add_u32 v5, 161792, v5
    ds_write2_b32 v5, v20, v22 offset0:0 offset1:32
    v_mov_b32 v10, 159756
    v_mov_b32 v11, 1
    s_mov_b64 exec, 1
    ds_add_u32 v10, v11
    s_mov_b64 exec, -1
nocs1_6:
    s_add_u32 m0, s67, 53248
    s_add_u32 s52, s58, 196608
    buffer_load_dwordx4 v6, s[40:43], s52 offen lds
    s_add_u32 m0, s67, 57344
    s_add_u32 s52, s58, 229376
    buffer_load_dwordx4 v6, s[40:43], s52 offen lds
    s_add_u32 m0, s67, 61440
    s_add_u32 s52, s58, 262144
    buffer_load_dwordx4 v6, s[40:43], s52 offen lds
    s_add_u32 m0, s67, 65536
    s_add_u32 s52, s58, 294912
    buffer_load_dwordx4 v6, s[40:43], s52 offen lds
    s_add_u32 m0, s67, 69632
    s_add_u32 s52, s58, 327680
    buffer_load_dwordx4 v6, s[40:43], s52 offen lds
    s_add_u32 m0, s67, 73728
    s_add_u32 s52, s58, 360448
    buffer_load_dwordx4 v6, s[40:43], s52 offen lds
    s_add_u32 m0, s67, 77824
    s_add_u32 s52, s58, 393216
    buffer_load_dwordx4 v6, s[40:43], s52 offen lds
    s_add_u32 m0, s67, 81920
    s_add_u32 s52, s58, 425984
    buffer_load_dwordx4 v6, s[40:43], s52 offen lds
    s_add_u32 m0, s67, 86016
    s_add_u32 s52, s58, 458752
    buffer_load_dwordx4 v6, s[40:43], s52 offen lds
    s_add_u32 m0, s67, 90112
    s_add_u32 s52, s58, 491520
    buffer_load_dwordx4 v6, s[40:43], s52 offen lds
    s_waitcnt vmcnt(0)
    v_mov_b32 v10, 159764
    v_mov_b32 v11, 1
    s_mov_b64 exec, 1
    ds_add_u32 v10, v11
    s_mov_b64 exec, -1
    s_cmp_lg_u32 s46, 0
    s_cbranch_scc1 k_loc_7
    s_mov_b32 s10, 0x3fffe
poll_8:
    s_and_b32 vcc_lo, s10, 15
    s_cbranch_scc0 poll_8_g
    buffer_load_dword v5, v12, s[28:31], 0 offen sc1
poll_chk_10:
    s_waitcnt vmcnt(0)
    v_cmp_ne_u32 vcc, s3, v5
    s_nop 0
    s_cbranch_vccz poll_done_9
    s_sleep 2
    s_sub_u32 s10, s10, 1
    s_cbranch_scc0 poll_8
    s_branch poll_done_9
poll_8_g:
    buffer_load_dword v5, v15, s[28:31], 0 offen sc1
    s_branch poll_chk_10
poll_done_9:
k_loc_7:
    s_mov_b32 s10, 0x3fffe
poll_11:
    s_and_b32 vcc_lo, s10, 15
    s_cbranch_scc0 poll_11_g
    buffer_load_dword v5, v18, s[28:31], 0 offen sc1
poll_chk_13:
    s_waitcnt vmcnt(0)
    v_cmp_ne_u32 vcc, s3, v5
    s_nop 0
    s_cbranch_vccz poll_done_12
    s_sleep 2
    s_sub_u32 s10, s10, 1
    s_cbranch_scc0 poll_11
    s_branch poll_done_12
poll_11_g:
    buffer_load_dword v5, v19, s[28:31], 0 offen sc1
    s_branch poll_chk_13
poll_done_12:
    s_lshl_b32 m0, s44, 12
    s_nop 0
    buffer_load_dwordx4 v2, s[28:31], s74 offen offset:0 sc1 lds
    buffer_load_dwordx4 v2, s[28:31], s74 offen offset:1024 sc1 lds
    buffer_load_dwordx4 v2, s[28:31], s74 offen offset:2048 sc1 lds
    buffer_load_dwordx4 v2, s[28:31], s74 offen offset:3072 sc1 lds
    s_mov_b32 s60, s44
    s_lshl_b32 s52, s51, 6
    s_lshl_b32 s53, s50, 3
    s_add_u32 s52, s52, s53
    s_add_u32 s52, s52, s60
    s_lshl_b32 s52, s52, 10
    buffer_load_dwordx4 v[124:127], v2, s[28:31], s52 offen sc1
    s_add_u32 s52, s52, 4096
    buffer_load_dwordx4 v[132:135], v2, s[28:31], s52 offen sc1
    s_mov_b32 s98, s75
    buffer_load_dword v18, v14, s[28:31], 0 offen sc1
    s_mov_b32 s64, 0xffffffff
    s_mov_b32 s65, 0xfffffff0
    s_mov_b32 s66, 0xfffffffe
    s_mov_b32 s67, 0xffffffe0
    s_mov_b32 s68, 0xfffffffc
    s_mov_b32 s69, 0xffffffc0
    s_mov_b32 s70, 0xfffffff8
    s_mov_b32 s71, 0xffffff80
    s_mov_b32 s72, 0xffffff00
    s_mov_b32 s73, 0xfffff000
    s_mov_b32 s74, 0xfffffe00
    s_mov_b32 s75, 0xffffe000
    s_mov_b32 s76, 0xfffffc00
    s_mov_b32 s77, 0xffffc000
    s_mov_b32 s78, 0xfffff800
    s_mov_b32 s79, 0xffff8000
    s_mov_b32 s80, 0xffff0000
    s_mov_b32 s81, 0xfff00000
    s_mov_b32 s82, 0xfffe0000
    s_mov_b32 s83, 0xffe00000
    s_mov_b32 s84, 0xfffc0000
    s_mov_b32 s85, 0xffc00000
    s_mov_b32 s86, 0xfff80000
    s_mov_b32 s87, 0xff800000
    s_mov_b32 s88, 0xff000000
    s_mov_b32 s89, 0xf0000000
    s_mov_b32 s90, 0xfe000000
    s_mov_b32 s91, 0xe0000000
    s_mov_b32 s92, 0xfc000000
    s_mov_b32 s93, 0xc0000000
    s_mov_b32 s94, 0xf8000000
    s_mov_b32 s95, 0x80000000
    v_mov_b32 v10, 0xffff
    v_mov_b32 v11, 0xffff0000
    v_cndmask_b32 v240, 0, v10, s[64:65]
    v_cndmask_b32 v5, 0, v11, s[66:67]
    v_or_b32 v240, v240, v5
    v_cndmask_b32 v241, 0, v10, s[68:69]
    v_cndmask_b32 v5, 0, v11, s[70:71]
    v_or_b32 v241, v241, v5
    v_cndmask_b32 v242, 0, v10, s[72:73]
    v_cndmask_b32 v5, 0, v11, s[74:75]
    v_or_b32 v242, v242, v5
    v_cndmask_b32 v243, 0, v10, s[76:77]
    v_cndmask_b32 v5, 0, v11, s[78:79]
    v_or_b32 v243, v243, v5
    v_cndmask_b32 v244, 0, v10, s[80:81]
    v_cndmask_b32 v5, 0, v11, s[82:83]
    v_or_b32 v244, v244, v5
    v_cndmask_b32 v245, 0, v10, s[84:85]
    v_cndmask_b32 v5, 0, v11, s[86:87]
    v_or_b32 v245, v245, v5
    v_cndmask_b32 v246, 0, v10, s[88:89]
    v_cndmask_b32 v5, 0, v11, s[90:91]
    v_or_b32 v246, v246, v5
    v_cndmask_b32 v247, 0, v10, s[92:93]
    v_cndmask_b32 v5, 0, v11, s[94:95]
    v_or_b32 v247, v247, v5
    s_setprio 1
    s_waitcnt vmcnt(0)
    v_cmp_ne_u32 vcc, s3, v18
    v_mov_b32 v10, 159768
    v_mov_b32 v11, 1
    s_mov_b64 exec, 1
    ds_add_u32 v10, v11
    s_mov_b64 exec, -1
    s_cbranch_vccz v_go_15
    s_mov_b32 s10, 0x3fffe
poll_16:
    s_and_b32 vcc_lo, s10, 15
    s_cbranch_scc0 poll_16_g
    buffer_load_dword v5, v14, s[28:31], 0 offen sc1
poll_chk_18:
    s_waitcnt vmcnt(0)
    v_cmp_ne_u32 vcc, s3, v5
    s_nop 0
    s_cbranch_vccz poll_done_17
    s_sleep 2
    s_sub_u32 s10, s10, 1
    s_cbranch_scc0 poll_16
    s_branch poll_done_17
poll_16_g:
    buffer_load_dword v5, v13, s[28:31], 0 offen sc1
    s_branch poll_chk_18
poll_done_17:
v_go_15:
    v_mov_b32 v10, 159772
    s_mov_b32 s10, 0x200000
aw_19:
    ds_read_b32 v11, v10
    s_waitcnt lgkmcnt(0)
    v_cmp_gt_u32 vcc, 4, v11
    s_nop 0
    s_cbranch_vccz aw_done_20
    s_sleep 1
    s_sub_u32 s10, s10, 1
    s_cbranch_scc0 aw_19
aw_done_20:
    s_lshl_b32 m0, s44, 12
    s_add_u32 m0, m0, 16384
    s_nop 0
    buffer_load_dwordx4 v2, s[28:31], s98 offen offset:0 sc1 lds
    buffer_load_dwordx4 v2, s[28:31], s98 offen offset:1024 sc1 lds
    buffer_load_dwordx4 v2, s[28:31], s98 offen offset:2048 sc1 lds
    buffer_load_dwordx4 v2, s[28:31], s98 offen offset:3072 sc1 lds
v_late_14:
    v_mov_b32 v10, 159768
    s_mov_b32 s10, 0x200000
aw_21:
    ds_read_b32 v11, v10
    s_waitcnt lgkmcnt(0)
    v_cmp_gt_u32 vcc, 4, v11
    s_nop 0
    s_cbranch_vccz aw_done_22
    s_sleep 1
    s_sub_u32 s10, s10, 1
    s_cbranch_scc0 aw_21
aw_done_22:
    s_call_b64 s[0:1], SUB_ATT
    buffer_store_dwordx4 v[128:131], v2, s[28:31], s62 offen sc1
    v_mov_b64 v[124:125], v[132:133]
    v_mov_b64 v[126:127], v[134:135]
    s_add_u32 s60, s44, 4
    s_mov_b64 s[32:33], s[18:19]
    s_mov_b32 s34, 1409024
    s_mov_b32 s35, 0x20000
    s_lshl_b32 s52, s50, 5
    s_add_u32 s52, s52, s51
    s_lshl_b32 s52, s52, 2
    s_add_u32 s52, s52, s44
    s_mul_i32 s52, s52, 1408
    v_min_u32 v5, 10, v1
    v_lshlrev_b32 v5, 7, v5
    buffer_load_dword v15, v5, s[32:35], s52 offen
    s_call_b64 s[0:1], SUB_ATT
    buffer_store_dwordx4 v[128:131], v2, s[28:31], s62 offen sc1
    s_waitcnt vmcnt(0)
    v_mov_b32 v5, s3
    s_add_u32 s10, s61, 65536
    s_mov_b64 exec, 1
    buffer_store_dword v5, off, s[28:31], s10
    s_cmp_lg_u32 s2, 0
    s_cbranch_scc1 gf_23
    buffer_store_dword v5, off, s[28:31], s61 sc1
gf_23:
    s_mov_b64 exec, -1
    s_setprio 0
    s_mov_b64 s[32:33], s[18:19]
    s_mov_b32 s34, 1409024
    s_mov_b32 s35, 0x20000
    s_mov_b64 s[40:41], s[22:23]
    s_mov_b32 s42, 2097152
    s_mov_b32 s43, 0x20000
    s_lshl_b32 s58, s48, 7
    s_lshl_b32 s52, s44, 13
    s_add_u32 s58, s58, s52
    s_lshl_b32 s59, s44, 10
    s_mul_i32 s60, s49, 88064
    s_lshl_b32 s52, s46, 10
    s_add_u32 s60, s60, s52
    s_add_u32 s60, s60, 14680064
    v_bfe_u32 v5, v1, 2, 2
    v_lshlrev_b32 v7, 2, v4
    v_add_u32 v7, v7, v5
    v_lshlrev_b32 v7, 7, v7
    v_lshrrev_b32 v5, 1, v5
    v_xor_b32 v5, s46, v5
    v_lshl_add_u32 v7, v5, 6, v7
    v_bfe_u32 v5, v1, 4, 1
    v_lshl_add_u32 v7, v5, 5, v7
    v_and_b32 v5, 3, v1
    v_lshl_add_u32 v7, v5, 3, v7
    s_lshl_b32 s52, s46, 11
    v_add_u32 v7, s52, v7
    v_xor_b32 v8, 64, v7
    v_add_u32 v12, 57344, v7
    v_add_u32 v13, 57344, v8
    v_add_u32 v14, 114688, v7
    v_add_u32 v15, 114688, v8
    v_min_u32 v10, 10, v1
    v_lshlrev_b32 v10, 2, v10
    s_lshl_b32 s52, s49, 7
    s_add_u32 s64, s52, 20791296
    s_add_u32 s65, s64, 76
    s_lshl_b32 s61, s49, 15
    s_lshl_b32 s62, s48, 12
    s_add_u32 s61, s61, s62
    s_lshl_b32 s62, s46, 11
    s_add_u32 s61, s61, s62
    s_add_u32 s61, s61, 12582912
    s_add_u32 s62, s48, 11
    s_lshl_b32 s62, s62, 2
    s_add_u32 s62, s62, s52
    s_add_u32 s62, s62, 20791296
    v_add_u32 v11, 65536, v10
    s_lshl_b32 s56, s44, 12
    s_add_u32 s56, s56, 32768
    s_xor_b32 s57, s56, 0x2000
    v_mov_b32 v16, 159760
    s_mov_b32 s10, 0x200000
aw_24:
    ds_read_b32 v17, v16
    s_waitcnt lgkmcnt(0)
    v_cmp_gt_u32 vcc, 4, v17
    s_nop 0
    s_cbranch_vccz aw_done_25
    s_sleep 1
    s_sub_u32 s10, s10, 1
    s_cbranch_scc0 aw_24
aw_done_25:
    v_mov_b32 v16, 159776
    s_mov_b32 s10, 0x200000
aw_26:
    ds_read_b32 v17, v16
    s_waitcnt lgkmcnt(0)
    v_cmp_gt_u32 vcc, 4, v17
    s_nop 0
    s_cbranch_vccz aw_done_27
    s_sleep 1
    s_sub_u32 s10, s10, 1
    s_cbranch_scc0 aw_26
aw_done_27:
    s_add_u32 m0, s59, 4096
    s_add_u32 s52, s58, 0
    buffer_load_dwordx4 v6, s[32:35], s52 offen lds
    s_add_u32 m0, s59, 8192
    s_add_u32 s52, s58, 32768
    buffer_load_dwordx4 v6, s[32:35], s52 offen lds
    s_add_u32 m0, s59, 12288
    s_add_u32 s52, s58, 131072
    buffer_load_dwordx4 v6, s[32:35], s52 offen lds
    s_add_u32 m0, s59, 16384
    s_add_u32 s52, s58, 163840
    buffer_load_dwordx4 v6, s[32:35], s52 offen lds
    s_add_u32 m0, s59, 20480
    s_add_u32 s52, s58, 262144
    buffer_load_dwordx4 v6, s[32:35], s52 offen lds
    s_add_u32 m0, s59, 24576
    s_add_u32 s52, s58, 294912
    buffer_load_dwordx4 v6, s[32:35], s52 offen lds
    s_add_u32 m0, s59, 28672
    s_add_u32 s52, s58, 393216
    buffer_load_dwordx4 v6, s[32:35], s52 offen lds
    v_mov_b32 v16, 159784
    s_mov_b32 s10, 0x200000
aw_28:
    ds_read_b32 v17, v16
    s_waitcnt lgkmcnt(0)
    v_cmp_gt_u32 vcc, 4, v17
    s_nop 0
    s_cbranch_vccz aw_done_29
    s_sleep 1
    s_sub_u32 s10, s10, 1
    s_cbranch_scc0 aw_28
aw_done_29:
    s_sub_u32 s52, s61, 4194304
    buffer_load_dwordx4 v[248:251], v2, s[28:31], s52 offen sc1
    buffer_load_dwordx4 v[252:255], v2, s[28:31], s52 offen offset:1024 sc1
    v_lshlrev_b32 v5, 4, v3
    s_lshl_b32 s54, s49, 9
    s_add_u32 s54, s54, 20578304
    s_mov_b32 s10, 0x20000
rs_30:
    buffer_load_dwordx4 v[72:75], v5, s[28:31], s54 offen offset:0 sc1
    s_waitcnt vmcnt(0)
    v_cmp_ne_u32 vcc, s3, v75
    s_nop 0
    s_cbranch_vccz rs_done_31
    s_sub_u32 s10, s10, 1
    s_cbranch_scc0 rs_30
rs_done_31:
    v_mov_b32 v16, 159808
    s_mov_b32 s10, 0x200000
aw_32:
    ds_read_b32 v17, v16
    s_waitcnt lgkmcnt(0)
    v_cmp_gt_u32 vcc, 4, v17
    s_nop 0
    s_cbranch_vccz aw_done_33
    s_sleep 1
    s_sub_u32 s10, s10, 1
    s_cbranch_scc0 aw_32
aw_done_33:
    s_sub_u32 s52, s96, 11
    s_cmp_lt_u32 s52, 4
    s_cbranch_scc1 w4s_34
    s_add_u32 m0, s59, 32768
    s_add_u32 s52, s58, 425984
    buffer_load_dwordx4 v6, s[32:35], s52 offen lds
    s_add_u32 m0, s59, 36864
    s_add_u32 s52, s58, 524288
    buffer_load_dwordx4 v6, s[32:35], s52 offen lds
    s_add_u32 m0, s59, 40960
    s_add_u32 s52, s58, 557056
    buffer_load_dwordx4 v6, s[32:35], s52 offen lds
    s_add_u32 m0, s59, 45056
    s_add_u32 s52, s58, 655360
    buffer_load_dwordx4 v6, s[32:35], s52 offen lds
    s_add_u32 m0, s59, 49152
    s_add_u32 s52, s58, 688128
    buffer_load_dwordx4 v6, s[32:35], s52 offen lds
    s_add_u32 m0, s59, 53248
    s_add_u32 s52, s58, 786432
    buffer_load_dwordx4 v6, s[32:35], s52 offen lds
    s_add_u32 m0, s59, 57344
    s_add_u32 s52, s58, 819200
    buffer_load_dwordx4 v6, s[32:35], s52 offen lds
w4s_34:
    v_mov_b32 v16, 159812
    s_mov_b32 s10, 0x200000
aw_35:
    ds_read_b32 v17, v16
    s_waitcnt lgkmcnt(0)
    v_cmp_gt_u32 vcc, 4, v17
    s_nop 0
    s_cbranch_vccz aw_done_36
    s_sleep 1
    s_sub_u32 s10, s10, 1
    s_cbranch_scc0 aw_35
aw_done_36:
    s_sub_u32 s52, s96, 11
    s_cmp_lt_u32 s52, 4
    s_cbranch_scc1 w4s_37
    s_add_u32 m0, s59, 61440
    s_add_u32 s52, s58, 917504
    buffer_load_dwordx4 v6, s[32:35], s52 offen lds
    s_add_u32 m0, s59, 65536
    s_add_u32 s52, s58, 950272
    buffer_load_dwordx4 v6, s[32:35], s52 offen lds
    s_add_u32 m0, s59, 69632
    s_add_u32 s52, s58, 1048576
    buffer_load_dwordx4 v6, s[32:35], s52 offen lds
    s_add_u32 m0, s59, 73728
    s_add_u32 s52, s58, 1081344
    buffer_load_dwordx4 v6, s[32:35], s52 offen lds
    s_add_u32 m0, s59, 77824
    s_add_u32 s52, s58, 1179648
    buffer_load_dwordx4 v6, s[32:35], s52 offen lds
    s_add_u32 m0, s59, 81920
    s_add_u32 s52, s58, 1212416
    buffer_load_dwordx4 v6, s[32:35], s52 offen lds
    s_add_u32 m0, s59, 86016
    s_add_u32 s52, s58, 1310720
    buffer_load_dwordx4 v6, s[32:35], s52 offen lds
    s_add_u32 m0, s59, 90112
    s_add_u32 s52, s58, 1343488
    buffer_load_dwordx4 v6, s[32:35], s52 offen lds
w4s_37:
    v_mov_b32 v16, 159816
    s_mov_b32 s10, 0x200000
aw_38:
    ds_read_b32 v17, v16
    s_waitcnt lgkmcnt(0)
    v_cmp_gt_u32 vcc, 4, v17
    s_nop 0
    s_cbranch_vccz aw_done_39
    s_sleep 1
    s_sub_u32 s10, s10, 1
    s_cbranch_scc0 aw_38
aw_done_39:
    s_add_u32 m0, s59, 94208
    s_add_u32 s52, s58, 65536
    buffer_load_dwordx4 v6, s[32:35], s52 offen lds
    s_add_u32 m0, s59, 98304
    s_add_u32 s52, s58, 98304
    buffer_load_dwordx4 v6, s[32:35], s52 offen lds
    s_add_u32 m0, s59, 102400
    s_add_u32 s52, s58, 196608
    buffer_load_dwordx4 v6, s[32:35], s52 offen lds
    s_add_u32 m0, s59, 106496
    s_add_u32 s52, s58, 229376
    buffer_load_dwordx4 v6, s[32:35], s52 offen lds
    s_add_u32 m0, s59, 110592
    s_add_u32 s52, s58, 327680
    buffer_load_dwordx4 v6, s[32:35], s52 offen lds
    s_add_u32 m0, s59, 114688
    s_add_u32 s52, s58, 360448
    buffer_load_dwordx4 v6, s[32:35], s52 offen lds
    s_add_u32 m0, s59, 118784
    s_add_u32 s52, s58, 458752
    buffer_load_dwordx4 v6, s[32:35], s52 offen lds
    s_add_u32 m0, s59, 122880
    s_add_u32 s52, s58, 491520
    buffer_load_dwordx4 v6, s[32:35], s52 offen lds
    v_mov_b32 v16, 159820
    s_mov_b32 s10, 0x200000
aw_40:
    ds_read_b32 v17, v16
    s_waitcnt lgkmcnt(0)
    v_cmp_gt_u32 vcc, 4, v17
    s_nop 0
    s_cbranch_vccz aw_done_41
    s_sleep 1
    s_sub_u32 s10, s10, 1
    s_cbranch_scc0 aw_40
aw_done_41:
    s_add_u32 m0, s59, 126976
    s_add_u32 s52, s58, 589824
    buffer_load_dwordx4 v6, s[32:35], s52 offen lds
    s_add_u32 m0, s59, 131072
    s_add_u32 s52, s58, 622592
    buffer_load_dwordx4 v6, s[32:35], s52 offen lds
    s_add_u32 m0, s59, 135168
    s_add_u32 s52, s58, 720896
    buffer_load_dwordx4 v6, s[32:35], s52 offen lds
    s_add_u32 m0, s59, 139264
    s_add_u32 s52, s58, 753664
    buffer_load_dwordx4 v6, s[32:35], s52 offen lds
    s_add_u32 m0, s59, 143360
    s_add_u32 s52, s58, 851968
    buffer_load_dwordx4 v6, s[32:35], s52 offen lds
    s_add_u32 m0, s59, 147456
    s_add_u32 s52, s58, 884736
    buffer_load_dwordx4 v6, s[32:35], s52 offen lds
    s_add_u32 m0, s59, 151552
    s_add_u32 s52, s58, 983040
    buffer_load_dwordx4 v6, s[32:35], s52 offen lds
    s_add_u32 m0, s59, 155648
    s_add_u32 s52, s58, 1015808
    buffer_load_dwordx4 v6, s[32:35], s52 offen lds
    s_add_u32 m0, s59, 0
    s_add_u32 s52, s58, 1114112
    buffer_load_dwordx4 v6, s[32:35], s52 offen lds
    buffer_load_dword v5, v11, s[28:31], s64 offen sc1
    s_waitcnt vmcnt(0)
    v_cmp_ne_u32 vcc, s3, v5
    v_mov_b32 v16, 159780
    v_mov_b32 v17, 1
    s_mov_b64 exec, 1
    ds_add_u32 v16, v17
    s_mov_b64 exec, -1
    s_cbranch_vccz poll_done_43
    s_mov_b32 s10, 0x3fffe
poll_42:
    s_and_b32 vcc_lo, s10, 15
    s_cbranch_scc0 poll_42_g
    buffer_load_dword v5, v11, s[28:31], s64 offen sc1
poll_chk_44:
    s_waitcnt vmcnt(0)
    v_cmp_ne_u32 vcc, s3, v5
    s_nop 0
    s_cbranch_vccz poll_done_43
    s_sleep 2
    s_sub_u32 s10, s10, 1
    s_cbranch_scc0 poll_42
    s_branch poll_done_43
poll_42_g:
    buffer_load_dword v5, v10, s[28:31], s64 offen sc1
    s_branch poll_chk_44
poll_done_43:
    buffer_load_dwordx4 v[76:79], v2, s[28:31], s60 offen offset:0 sc1
    buffer_load_dwordx4 v[80:83], v2, s[28:31], s60 offen offset:2048 sc1
    s_add_u32 s60, s60, 8192
    buffer_load_dwordx4 v[84:87], v2, s[28:31], s60 offen offset:0 sc1
    buffer_load_dwordx4 v[88:91], v2, s[28:31], s60 offen offset:2048 sc1
    s_add_u32 s60, s60, 8192
    buffer_load_dwordx4 v[92:95], v2, s[28:31], s60 offen offset:0 sc1
    buffer_load_dwordx4 v[96:99], v2, s[28:31], s60 offen offset:2048 sc1
    s_add_u32 s60, s60, 8192
    buffer_load_dwordx4 v[100:103], v2, s[28:31], s60 offen offset:0 sc1
    buffer_load_dwordx4 v[104:107], v2, s[28:31], s60 offen offset:2048 sc1
    s_add_u32 s60, s60, 8192
    buffer_load_dwordx4 v[108:111], v2, s[28:31], s60 offen offset:0 sc1
    buffer_load_dwordx4 v[112:115], v2, s[28:31], s60 offen offset:2048 sc1
    s_add_u32 s60, s60, 8192
    v_mov_b32 v16, 159780
    s_mov_b32 s10, 0x200000
aw_45:
    ds_read_b32 v17, v16
    s_waitcnt lgkmcnt(0)
    v_cmp_gt_u32 vcc, 4, v17
    s_nop 0
    s_cbranch_vccz aw_done_46
    s_sleep 1
    s_sub_u32 s10, s10, 1
    s_cbranch_scc0 aw_45
aw_done_46:
    ds_read_b64_tr_b16 v[48:49], v7 offset:4096
    ds_read_b64_tr_b16 v[50:51], v7 offset:5120
    ds_read_b64_tr_b16 v[52:53], v8 offset:4096
    ds_read_b64_tr_b16 v[54:55], v8 offset:5120
    ds_read_b64_tr_b16 v[56:57], v7 offset:8192
    ds_read_b64_tr_b16 v[58:59], v7 offset:9216
    ds_read_b64_tr_b16 v[60:61], v8 offset:8192
    ds_read_b64_tr_b16 v[62:63], v8 offset:9216
    buffer_load_dwordx4 v[116:119], v2, s[28:31], s60 offen offset:0 sc1
    s_waitcnt vmcnt(10) lgkmcnt(4)
    v_mfma_f32_32x32x16_bf16 v[16:31], v[48:51], v[76:79], 0
    ds_read_b64_tr_b16 v[64:65], v7 offset:12288
    ds_read_b64_tr_b16 v[66:67], v7 offset:13312
    ds_read_b64_tr_b16 v[68:69], v8 offset:12288
    ds_read_b64_tr_b16 v[70:71], v8 offset:13312
    v_mfma_f32_32x32x16_bf16 v[32:47], v[52:55], v[76:79], 0
    buffer_load_dwordx4 v[120:123], v2, s[28:31], s60 offen offset:2048 sc1
    s_add_u32 s60, s60, 8192
    s_waitcnt vmcnt(10) lgkmcnt(4)
    v_mfma_f32_32x32x16_bf16 v[16:31], v[56:59], v[80:83], v[16:31]
    ds_read_b64_tr_b16 v[48:49], v7 offset:16384
    ds_read_b64_tr_b16 v[50:51], v7 offset:17408
    ds_read_b64_tr_b16 v[52:53], v8 offset:16384
    ds_read_b64_tr_b16 v[54:55], v8 offset:17408
    v_mfma_f32_32x32x16_bf16 v[32:47], v[60:63], v[80:83], v[32:47]
    buffer_load_dwordx4 v[124:127], v2, s[28:31], s60 offen offset:0 sc1
    s_waitcnt vmcnt(10) lgkmcnt(4)
    v_mfma_f32_32x32x16_bf16 v[16:31], v[64:67], v[84:87], v[16:31]
    ds_read_b64_tr_b16 v[56:57], v7 offset:20480
    ds_read_b64_tr_b16 v[58:59], v7 offset:21504
    ds_read_b64_tr_b16 v[60:61], v8 offset:20480
    ds_read_b64_tr_b16 v[62:63], v8 offset:21504
    v_mfma_f32_32x32x16_bf16 v[32:47], v[68:71], v[84:87], v[32:47]
    buffer_load_dwordx4 v[128:131], v2, s[28:31], s60 offen offset:2048 sc1
    s_add_u32 s60, s60, 8192
    s_waitcnt vmcnt(10) lgkmcnt(4)
    v_mfma_f32_32x32x16_bf16 v[16:31], v[48:51], v[88:91], v[16:31]
    ds_read_b64_tr_b16 v[64:65], v7 offset:24576
    ds_read_b64_tr_b16 v[66:67], v7 offset:25600
    ds_read_b64_tr_b16 v[68:69], v8 offset:24576
    ds_read_b64_tr_b16 v[70:71], v8 offset:25600
    v_mfma_f32_32x32x16_bf16 v[32:47], v[52:55], v[88:91], v[32:47]
    buffer_load_dwordx4 v[132:135], v2, s[28:31], s60 offen offset:0 sc1
    s_waitcnt vmcnt(10) lgkmcnt(4)
    v_mfma_f32_32x32x16_bf16 v[16:31], v[56:59], v[92:95], v[16:31]
    ds_read_b64_tr_b16 v[48:49], v7 offset:28672
    ds_read_b64_tr_b16 v[50:51], v7 offset:29696
    ds_read_b64_tr_b16 v[52:53], v8 offset:28672
    ds_read_b64_tr_b16 v[54:55], v8 offset:29696
    v_mfma_f32_32x32x16_bf16 v[32:47], v[60:63], v[92:95], v[32:47]
    v_mov_b32 v72, 159800
    v_mov_b32 v73, 1
    s_mov_b64 exec, 1
    ds_add_u32 v72, v73
    s_mov_b64 exec, -1
    buffer_load_dwordx4 v[136:139], v2, s[28:31], s60 offen offset:2048 sc1
    s_add_u32 s60, s60, 8192
    s_waitcnt vmcnt(10) lgkmcnt(5)
    v_mfma_f32_32x32x16_bf16 v[16:31], v[64:67], v[96:99], v[16:31]
    ds_read_b64_tr_b16 v[56:57], v7 offset:32768
    ds_read_b64_tr_b16 v[58:59], v7 offset:33792
    ds_read_b64_tr_b16 v[60:61], v8 offset:32768
    ds_read_b64_tr_b16 v[62:63], v8 offset:33792
    v_mfma_f32_32x32x16_bf16 v[32:47], v[68:71], v[96:99], v[32:47]
    buffer_load_dwordx4 v[140:143], v2, s[28:31], s60 offen offset:0 sc1
    s_waitcnt vmcnt(10) lgkmcnt(5)
    v_mfma_f32_32x32x16_bf16 v[16:31], v[48:51], v[100:103], v[16:31]
    ds_read_b64_tr_b16 v[64:65], v7 offset:36864
    ds_read_b64_tr_b16 v[66:67], v7 offset:37888
    ds_read_b64_tr_b16 v[68:69], v8 offset:36864
    ds_read_b64_tr_b16 v[70:71], v8 offset:37888
    v_mfma_f32_32x32x16_bf16 v[32:47], v[52:55], v[100:103], v[32:47]
    buffer_load_dwordx4 v[144:147], v2, s[28:31], s60 offen offset:2048 sc1
    s_add_u32 s60, s60, 8192
    s_waitcnt vmcnt(10) lgkmcnt(4)
    v_mfma_f32_32x32x16_bf16 v[16:31], v[56:59], v[104:107], v[16:31]
    ds_read_b64_tr_b16 v[48:49], v7 offset:40960
    ds_read_b64_tr_b16 v[50:51], v7 offset:41984
    ds_read_b64_tr_b16 v[52:53], v8 offset:40960
    ds_read_b64_tr_b16 v[54:55], v8 offset:41984
    v_mfma_f32_32x32x16_bf16 v[32:47], v[60:63], v[104:107], v[32:47]
    v_mov_b32 v72, 159800
    ds_read_b32 v73, v72
    buffer_load_dwordx4 v[148:151], v2, s[28:31], s60 offen offset:0 sc1
    s_waitcnt vmcnt(10) lgkmcnt(5)
    v_mfma_f32_32x32x16_bf16 v[16:31], v[64:67], v[108:111], v[16:31]
    ds_read_b64_tr_b16 v[56:57], v7 offset:45056
    ds_read_b64_tr_b16 v[58:59], v7 offset:46080
    ds_read_b64_tr_b16 v[60:61], v8 offset:45056
    ds_read_b64_tr_b16 v[62:63], v8 offset:46080
    v_mfma_f32_32x32x16_bf16 v[32:47], v[68:71], v[108:111], v[32:47]
    buffer_load_dwordx4 v[152:155], v2, s[28:31], s60 offen offset:2048 sc1
    s_add_u32 s60, s60, 8192
    s_waitcnt vmcnt(10) lgkmcnt(5)
    v_mfma_f32_32x32x16_bf16 v[16:31], v[48:51], v[112:115], v[16:31]
    ds_read_b64_tr_b16 v[64:65], v7 offset:49152
    ds_read_b64_tr_b16 v[66:67], v7 offset:50176
    ds_read_b64_tr_b16 v[68:69], v8 offset:49152
    ds_read_b64_tr_b16 v[70:71], v8 offset:50176
    v_mfma_f32_32x32x16_bf16 v[32:47], v[52:55], v[112:115], v[32:47]
    s_waitcnt lgkmcnt(8)
    v_cmp_gt_u32 vcc, 4, v73
    s_nop 0
    s_cbranch_vccnz pk_47_s
pk_47:
    s_add_u32 m0, s59, 4096
    s_add_u32 s52, s58, 1146880
    buffer_load_dwordx4 v6, s[32:35], s52 offen lds
    buffer_load_dwordx4 v[156:159], v2, s[28:31], s60 offen offset:0 sc1
    s_waitcnt vmcnt(11) lgkmcnt(4)
    v_mfma_f32_32x32x16_bf16 v[16:31], v[56:59], v[116:119], v[16:31]
    ds_read_b64_tr_b16 v[48:49], v7 offset:53248
    ds_read_b64_tr_b16 v[50:51], v7 offset:54272
    ds_read_b64_tr_b16 v[52:53], v8 offset:53248
    ds_read_b64_tr_b16 v[54:55], v8 offset:54272
    v_mfma_f32_32x32x16_bf16 v[32:47], v[60:63], v[116:119], v[32:47]
    s_add_u32 m0, s59, 8192
    s_add_u32 s52, s58, 1245184
    buffer_load_dwordx4 v6, s[32:35], s52 offen lds
    buffer_load_dwordx4 v[160:163], v2, s[28:31], s60 offen offset:2048 sc1
    s_add_u32 s60, s60, 8192
    s_waitcnt vmcnt(12) lgkmcnt(4)
    v_mfma_f32_32x32x16_bf16 v[16:31], v[64:67], v[120:123], v[16:31]
    ds_read_b64_tr_b16 v[56:57], v12 offset:0
    ds_read_b64_tr_b16 v[58:59], v12 offset:1024
    ds_read_b64_tr_b16 v[60:61], v13 offset:0
    ds_read_b64_tr_b16 v[62:63], v13 offset:1024
    v_mfma_f32_32x32x16_bf16 v[32:47], v[68:71], v[120:123], v[32:47]
    s_add_u32 m0, s59, 12288
    s_add_u32 s52, s58, 1277952
    buffer_load_dwordx4 v6, s[32:35], s52 offen lds
    v_mov_b32 v10, 0
    v_mov_b32 v11, 65536
    s_sub_u32 s60, s60, 86016
    buffer_load_dwordx4 v[164:167], v2, s[28:31], s60 offen offset:0 sc1
    s_waitcnt vmcnt(13) lgkmcnt(4)
    v_mfma_f32_32x32x16_bf16 v[16:31], v[48:51], v[124:127], v[16:31]
    ds_read_b64_tr_b16 v[64:65], v12 offset:4096
    ds_read_b64_tr_b16 v[66:67], v12 offset:5120
    ds_read_b64_tr_b16 v[68:69], v13 offset:4096
    ds_read_b64_tr_b16 v[70:71], v13 offset:5120
    v_mfma_f32_32x32x16_bf16 v[32:47], v[52:55], v[124:127], v[32:47]
    s_add_u32 m0, s59, 16384
    s_add_u32 s52, s58, 1376256
    buffer_load_dwordx4 v6, s[32:35], s52 offen lds
    buffer_load_dwordx4 v[168:171], v2, s[28:31], s60 offen offset:2048 sc1
    s_add_u32 s60, s60, 8192
    s_waitcnt vmcnt(14) lgkmcnt(4)
    v_mfma_f32_32x32x16_bf16 v[16:31], v[56:59], v[128:131], v[16:31]
    ds_read_b64_tr_b16 v[48:49], v12 offset:8192
    ds_read_b64_tr_b16 v[50:51], v12 offset:9216
    ds_read_b64_tr_b16 v[52:53], v13 offset:8192
    ds_read_b64_tr_b16 v[54:55], v13 offset:9216
    v_mfma_f32_32x32x16_bf16 v[32:47], v[60:63], v[128:131], v[32:47]
    buffer_load_dwordx4 v[172:175], v2, s[28:31], s60 offen offset:0 sc1
    s_waitcnt vmcnt(14) lgkmcnt(4)
    v_mfma_f32_32x32x16_bf16 v[16:31], v[64:67], v[132:135], v[16:31]
    ds_read_b64_tr_b16 v[56:57], v12 offset:12288
    ds_read_b64_tr_b16 v[58:59], v12 offset:13312
    ds_read_b64_tr_b16 v[60:61], v13 offset:12288
    ds_read_b64_tr_b16 v[62:63], v13 offset:13312
    v_mfma_f32_32x32x16_bf16 v[32:47], v[68:71], v[132:135], v[32:47]
    buffer_load_dwordx4 v[176:179], v2, s[28:31], s60 offen offset:2048 sc1
    s_add_u32 s60, s60, 8192
    s_waitcnt vmcnt(14) lgkmcnt(4)
    v_mfma_f32_32x32x16_bf16 v[16:31], v[48:51], v[136:139], v[16:31]
    ds_read_b64_tr_b16 v[64:65], v12 offset:16384
    ds_read_b64_tr_b16 v[66:67], v12 offset:17408
    ds_read_b64_tr_b16 v[68:69], v13 offset:16384
    ds_read_b64_tr_b16 v[70:71], v13 offset:17408
    v_mfma_f32_32x32x16_bf16 v[32:47], v[52:55], v[136:139], v[32:47]
    buffer_load_dwordx4 v[180:183], v2, s[28:31], s60 offen offset:0 sc1
    s_waitcnt vmcnt(14) lgkmcnt(4)
    v_mfma_f32_32x32x16_bf16 v[16:31], v[56:59], v[140:143], v[16:31]
    ds_read_b64_tr_b16 v[48:49], v12 offset:20480
    ds_read_b64_tr_b16 v[50:51], v12 offset:21504
    ds_read_b64_tr_b16 v[52:53], v13 offset:20480
    ds_read_b64_tr_b16 v[54:55], v13 offset:21504
    v_mfma_f32_32x32x16_bf16 v[32:47], v[60:63], v[140:143], v[32:47]
    buffer_load_dwordx4 v[184:187], v2, s[28:31], s60 offen offset:2048 sc1
    s_add_u32 s60, s60, 8192
    s_waitcnt vmcnt(14) lgkmcnt(4)
    v_mfma_f32_32x32x16_bf16 v[16:31], v[64:67], v[144:147], v[16:31]
    ds_read_b64_tr_b16 v[56:57], v12 offset:24576
    ds_read_b64_tr_b16 v[58:59], v12 offset:25600
    ds_read_b64_tr_b16 v[60:61], v13 offset:24576
    ds_read_b64_tr_b16 v[62:63], v13 offset:25600
    v_mfma_f32_32x32x16_bf16 v[32:47], v[68:71], v[144:147], v[32:47]
    buffer_load_dwordx4 v[188:191], v2, s[28:31], s60 offen offset:0 sc1
    s_waitcnt vmcnt(14) lgkmcnt(4)
    v_mfma_f32_32x32x16_bf16 v[16:31], v[48:51], v[148:151], v[16:31]
    ds_read_b64_tr_b16 v[64:65], v12 offset:28672
    ds_read_b64_tr_b16 v[66:67], v12 offset:29696
    ds_read_b64_tr_b16 v[68:69], v13 offset:28672
    ds_read_b64_tr_b16 v[70:71], v13 offset:29696
    v_mfma_f32_32x32x16_bf16 v[32:47], v[52:55], v[148:151], v[32:47]
    buffer_load_dwordx4 v[192:195], v2, s[28:31], s60 offen offset:2048 sc1
    s_add_u32 s60, s60, 8192
    s_waitcnt vmcnt(14) lgkmcnt(4)
    v_mfma_f32_32x32x16_bf16 v[16:31], v[56:59], v[152:155], v[16:31]
    ds_read_b64_tr_b16 v[48:49], v12 offset:32768
    ds_read_b64_tr_b16 v[50:51], v12 offset:33792
    ds_read_b64_tr_b16 v[52:53], v13 offset:32768
    ds_read_b64_tr_b16 v[54:55], v13 offset:33792
    v_mfma_f32_32x32x16_bf16 v[32:47], v[60:63], v[152:155], v[32:47]
    buffer_load_dwordx4 v[196:199], v2, s[28:31], s60 offen offset:0 sc1
    s_waitcnt vmcnt(13) lgkmcnt(4)
    v_mfma_f32_32x32x16_bf16 v[16:31], v[64:67], v[156:159], v[16:31]
    ds_read_b64_tr_b16 v[56:57], v12 offset:36864
    ds_read_b64_tr_b16 v[58:59], v12 offset:37888
    ds_read_b64_tr_b16 v[60:61], v13 offset:36864
    ds_read_b64_tr_b16 v[62:63], v13 offset:37888
    v_mfma_f32_32x32x16_bf16 v[32:47], v[68:71], v[156:159], v[32:47]
    buffer_load_dwordx4 v[200:203], v2, s[28:31], s60 offen offset:2048 sc1
    s_add_u32 s60, s60, 8192
    s_waitcnt vmcnt(12) lgkmcnt(4)
    v_mfma_f32_32x32x16_bf16 v[16:31], v[48:51], v[160:163], v[16:31]
    ds_read_b64_tr_b16 v[64:65], v12 offset:40960
    ds_read_b64_tr_b16 v[66:67], v12 offset:41984
    ds_read_b64_tr_b16 v[68:69], v13 offset:40960
    ds_read_b64_tr_b16 v[70:71], v13 offset:41984
    v_mfma_f32_32x32x16_bf16 v[32:47], v[52:55], v[160:163], v[32:47]
    buffer_load_dwordx4 v[204:207], v2, s[28:31], s60 offen offset:0 sc1
    s_waitcnt vmcnt(11) lgkmcnt(4)
    v_mfma_f32_32x32x16_bf16 v[16:31], v[56:59], v[164:167], v[16:31]
    ds_read_b64_tr_b16 v[48:49], v12 offset:45056
    ds_read_b64_tr_b16 v[50:51], v12 offset:46080
    ds_read_b64_tr_b16 v[52:53], v13 offset:45056
    ds_read_b64_tr_b16 v[54:55], v13 offset:46080
    v_mfma_f32_32x32x16_bf16 v[32:47], v[60:63], v[164:167], v[32:47]
    buffer_load_dwordx4 v[208:211], v2, s[28:31], s60 offen offset:2048 sc1
    s_add_u32 s60, s60, 8192
    s_waitcnt vmcnt(10) lgkmcnt(4)
    v_mfma_f32_32x32x16_bf16 v[16:31], v[64:67], v[168:171], v[16:31]
    ds_read_b64_tr_b16 v[56:57], v12 offset:49152
    ds_read_b64_tr_b16 v[58:59], v12 offset:50176
    ds_read_b64_tr_b16 v[60:61], v13 offset:49152
    ds_read_b64_tr_b16 v[62:63], v13 offset:50176
    v_mfma_f32_32x32x16_bf16 v[32:47], v[68:71], v[168:171], v[32:47]
    buffer_load_dwordx4 v[212:215], v2, s[28:31], s60 offen offset:0 sc1
    buffer_load_dword v75, v11, s[28:31], s62 offen sc1
    s_waitcnt vmcnt(11) lgkmcnt(4)
    v_mfma_f32_32x32x16_bf16 v[16:31], v[48:51], v[172:175], v[16:31]
    ds_read_b64_tr_b16 v[64:65], v12 offset:53248
    ds_read_b64_tr_b16 v[66:67], v12 offset:54272
    ds_read_b64_tr_b16 v[68:69], v13 offset:53248
    ds_read_b64_tr_b16 v[70:71], v13 offset:54272
    v_mfma_f32_32x32x16_bf16 v[32:47], v[52:55], v[172:175], v[32:47]
    buffer_load_dwordx4 v[216:219], v2, s[28:31], s60 offen offset:2048 sc1
    s_add_u32 s60, s60, 8192
    s_waitcnt vmcnt(11) lgkmcnt(4)
    v_mfma_f32_32x32x16_bf16 v[16:31], v[56:59], v[176:179], v[16:31]
    ds_read_b64_tr_b16 v[48:49], v14 offset:0
    ds_read_b64_tr_b16 v[50:51], v14 offset:1024
    ds_read_b64_tr_b16 v[52:53], v15 offset:0
    ds_read_b64_tr_b16 v[54:55], v15 offset:1024
    v_mfma_f32_32x32x16_bf16 v[32:47], v[60:63], v[176:179], v[32:47]
    buffer_load_dwordx4 v[220:223], v2, s[28:31], s60 offen offset:0 sc1
    s_waitcnt vmcnt(11) lgkmcnt(4)
    v_mfma_f32_32x32x16_bf16 v[16:31], v[64:67], v[180:183], v[16:31]
    ds_read_b64_tr_b16 v[56:57], v14 offset:4096
    ds_read_b64_tr_b16 v[58:59], v14 offset:5120
    ds_read_b64_tr_b16 v[60:61], v15 offset:4096
    ds_read_b64_tr_b16 v[62:63], v15 offset:5120
    v_mfma_f32_32x32x16_bf16 v[32:47], v[68:71], v[180:183], v[32:47]
    buffer_load_dwordx4 v[224:227], v2, s[28:31], s60 offen offset:2048 sc1
    s_add_u32 s60, s60, 8192
    s_waitcnt vmcnt(11) lgkmcnt(4)
    v_mfma_f32_32x32x16_bf16 v[16:31], v[48:51], v[184:187], v[16:31]
    ds_read_b64_tr_b16 v[64:65], v14 offset:8192
    ds_read_b64_tr_b16 v[66:67], v14 offset:9216
    ds_read_b64_tr_b16 v[68:69], v15 offset:8192
    ds_read_b64_tr_b16 v[70:71], v15 offset:9216
    v_mfma_f32_32x32x16_bf16 v[32:47], v[52:55], v[184:187], v[32:47]
    buffer_load_dwordx4 v[228:231], v2, s[28:31], s60 offen offset:0 sc1
    s_waitcnt vmcnt(11) lgkmcnt(4)
    v_mfma_f32_32x32x16_bf16 v[16:31], v[56:59], v[188:191], v[16:31]
    ds_read_b64_tr_b16 v[48:49], v14 offset:12288
    ds_read_b64_tr_b16 v[50:51], v14 offset:13312
    ds_read_b64_tr_b16 v[52:53], v15 offset:12288
    ds_read_b64_tr_b16 v[54:55], v15 offset:13312
    v_mfma_f32_32x32x16_bf16 v[32:47], v[60:63], v[188:191], v[32:47]
    buffer_load_dwordx4 v[232:235], v2, s[28:31], s60 offen offset:2048 sc1
    s_add_u32 s60, s60, 8192
    s_waitcnt vmcnt(11) lgkmcnt(4)
    v_mfma_f32_32x32x16_bf16 v[16:31], v[64:67], v[192:195], v[16:31]
    ds_read_b64_tr_b16 v[56:57], v14 offset:16384
    ds_read_b64_tr_b16 v[58:59], v14 offset:17408
    ds_read_b64_tr_b16 v[60:61], v15 offset:16384
    ds_read_b64_tr_b16 v[62:63], v15 offset:17408
    v_mfma_f32_32x32x16_bf16 v[32:47], v[68:71], v[192:195], v[32:47]
    v_mov_b32 v72, 159804
    v_mov_b32 v73, 1
    s_mov_b64 exec, 1
    ds_add_u32 v72, v73
    s_mov_b64 exec, -1
    buffer_load_dwordx4 v[236:239], v2, s[28:31], s60 offen offset:0 sc1
    s_waitcnt vmcnt(11) lgkmcnt(5)
    v_mfma_f32_32x32x16_bf16 v[16:31], v[48:51], v[196:199], v[16:31]
    ds_read_b64_tr_b16 v[64:65], v14 offset:20480
    ds_read_b64_tr_b16 v[66:67], v14 offset:21504
    ds_read_b64_tr_b16 v[68:69], v15 offset:20480
    ds_read_b64_tr_b16 v[70:71], v15 offset:21504
    v_mfma_f32_32x32x16_bf16 v[32:47], v[52:55], v[196:199], v[32:47]
    buffer_load_dwordx4 v[240:243], v2, s[28:31], s60 offen offset:2048 sc1
    s_add_u32 s60, s60, 8192
    s_waitcnt vmcnt(11) lgkmcnt(5)
    v_mfma_f32_32x32x16_bf16 v[16:31], v[56:59], v[200:203], v[16:31]
    ds_read_b64_tr_b16 v[48:49], v14 offset:24576
    ds_read_b64_tr_b16 v[50:51], v14 offset:25600
    ds_read_b64_tr_b16 v[52:53], v15 offset:24576
    ds_read_b64_tr_b16 v[54:55], v15 offset:25600
    v_mfma_f32_32x32x16_bf16 v[32:47], v[60:63], v[200:203], v[32:47]
    buffer_load_dwordx4 v[244:247], v2, s[28:31], s60 offen offset:0 sc1
    s_waitcnt vmcnt(11) lgkmcnt(4)
    v_mfma_f32_32x32x16_bf16 v[16:31], v[64:67], v[204:207], v[16:31]
    ds_read_b64_tr_b16 v[56:57], v14 offset:28672
    ds_read_b64_tr_b16 v[58:59], v14 offset:29696
    ds_read_b64_tr_b16 v[60:61], v15 offset:28672
    ds_read_b64_tr_b16 v[62:63], v15 offset:29696
    v_mfma_f32_32x32x16_bf16 v[32:47], v[68:71], v[204:207], v[32:47]
    s_waitcnt vmcnt(8)
    v_cmp_ne_u32 vcc, s3, v75
    s_nop 0
    s_cbranch_vccz fa_ok_48
    s_mov_b32 s10, 0x3fffe
poll_49:
    s_and_b32 vcc_lo, s10, 15
    s_cbranch_scc0 poll_49_g
    buffer_load_dword v75, v11, s[28:31], s62 offen sc1
poll_chk_51:
    s_waitcnt vmcnt(0)
    v_cmp_ne_u32 vcc, s3, v75
    s_nop 0
    s_cbranch_vccz poll_done_50
    s_sleep 2
    s_sub_u32 s10, s10, 1
    s_cbranch_scc0 poll_49
    s_branch poll_done_50
poll_49_g:
    buffer_load_dword v75, v10, s[28:31], s62 offen sc1
    s_branch poll_chk_51
poll_done_50:
fa_ok_48:
    buffer_load_dwordx4 v[76:79], v2, s[28:31], s61 offen sc1
    buffer_load_dwordx4 v[80:83], v2, s[28:31], s61 offen offset:1024 sc1
    s_waitcnt lgkmcnt(4)
    v_mfma_f32_32x32x16_bf16 v[16:31], v[48:51], v[208:211], v[16:31]
    ds_read_b64_tr_b16 v[64:65], v14 offset:32768
    ds_read_b64_tr_b16 v[66:67], v14 offset:33792
    ds_read_b64_tr_b16 v[68:69], v15 offset:32768
    ds_read_b64_tr_b16 v[70:71], v15 offset:33792
    v_mfma_f32_32x32x16_bf16 v[32:47], v[52:55], v[208:211], v[32:47]
    v_mov_b32 v72, 159804
    ds_read_b32 v73, v72
    s_waitcnt lgkmcnt(5)
    v_mfma_f32_32x32x16_bf16 v[16:31], v[56:59], v[212:215], v[16:31]
    ds_read_b64_tr_b16 v[48:49], v14 offset:36864
    ds_read_b64_tr_b16 v[50:51], v14 offset:37888
    ds_read_b64_tr_b16 v[52:53], v15 offset:36864
    ds_read_b64_tr_b16 v[54:55], v15 offset:37888
    v_mfma_f32_32x32x16_bf16 v[32:47], v[60:63], v[212:215], v[32:47]
    s_waitcnt vmcnt(9) lgkmcnt(5)
    v_mfma_f32_32x32x16_bf16 v[16:31], v[64:67], v[216:219], v[16:31]
    ds_read_b64_tr_b16 v[56:57], v14 offset:40960
    ds_read_b64_tr_b16 v[58:59], v14 offset:41984
    ds_read_b64_tr_b16 v[60:61], v15 offset:40960
    ds_read_b64_tr_b16 v[62:63], v15 offset:41984
    v_mfma_f32_32x32x16_bf16 v[32:47], v[68:71], v[216:219], v[32:47]
    s_waitcnt lgkmcnt(8)
    v_cmp_gt_u32 vcc, 4, v73
    s_nop 0
    s_cbranch_vccnz pk_52_s
pk_52:
    s_waitcnt vmcnt(8) lgkmcnt(4)
    v_mfma_f32_32x32x16_bf16 v[16:31], v[48:51], v[220:223], v[16:31]
    ds_read_b64_tr_b16 v[64:65], v7 offset:0
    ds_read_b64_tr_b16 v[66:67], v7 offset:1024
    ds_read_b64_tr_b16 v[68:69], v8 offset:0
    ds_read_b64_tr_b16 v[70:71], v8 offset:1024
    v_mfma_f32_32x32x16_bf16 v[32:47], v[52:55], v[220:223], v[32:47]
    s_waitcnt vmcnt(7) lgkmcnt(4)
    v_mfma_f32_32x32x16_bf16 v[16:31], v[56:59], v[224:227], v[16:31]
    ds_read_b64_tr_b16 v[48:49], v7 offset:4096
    ds_read_b64_tr_b16 v[50:51], v7 offset:5120
    ds_read_b64_tr_b16 v[52:53], v8 offset:4096
    ds_read_b64_tr_b16 v[54:55], v8 offset:5120
    v_mfma_f32_32x32x16_bf16 v[32:47], v[60:63], v[224:227], v[32:47]
    s_waitcnt vmcnt(6) lgkmcnt(4)
    v_mfma_f32_32x32x16_bf16 v[16:31], v[64:67], v[228:231], v[16:31]
    ds_read_b64_tr_b16 v[56:57], v7 offset:8192
    ds_read_b64_tr_b16 v[58:59], v7 offset:9216
    ds_read_b64_tr_b16 v[60:61], v8 offset:8192
    ds_read_b64_tr_b16 v[62:63], v8 offset:9216
    v_mfma_f32_32x32x16_bf16 v[32:47], v[68:71], v[228:231], v[32:47]
    s_waitcnt vmcnt(5) lgkmcnt(4)
    v_mfma_f32_32x32x16_bf16 v[16:31], v[48:51], v[232:235], v[16:31]
    ds_read_b64_tr_b16 v[64:65], v7 offset:12288
    ds_read_b64_tr_b16 v[66:67], v7 offset:13312
    ds_read_b64_tr_b16 v[68:69], v8 offset:12288
    ds_read_b64_tr_b16 v[70:71], v8 offset:13312
    v_mfma_f32_32x32x16_bf16 v[32:47], v[52:55], v[232:235], v[32:47]
    s_waitcnt vmcnt(4) lgkmcnt(4)
    v_mfma_f32_32x32x16_bf16 v[16:31], v[56:59], v[236:239], v[16:31]
    ds_read_b64_tr_b16 v[48:49], v7 offset:16384
    ds_read_b64_tr_b16 v[50:51], v7 offset:17408
    ds_read_b64_tr_b16 v[52:53], v8 offset:16384
    ds_read_b64_tr_b16 v[54:55], v8 offset:17408
    v_mfma_f32_32x32x16_bf16 v[32:47], v[60:63], v[236:239], v[32:47]
    s_waitcnt vmcnt(3) lgkmcnt(4)
    v_mfma_f32_32x32x16_bf16 v[16:31], v[64:67], v[240:243], v[16:31]
    v_mfma_f32_32x32x16_bf16 v[32:47], v[68:71], v[240:243], v[32:47]
    s_waitcnt vmcnt(2) lgkmcnt(0)
    v_mfma_f32_32x32x16_bf16 v[16:31], v[48:51], v[244:247], v[16:31]
    v_mfma_f32_32x32x16_bf16 v[32:47], v[52:55], v[244:247], v[32:47]
    v_add_u32 v12, s56, v2
    v_add_u32 v13, s57, v2
    s_nop 9
    ds_write_b128 v12, v[32:35] offset:0
    ds_write_b128 v12, v[36:39] offset:1024
    ds_write_b128 v12, v[40:43] offset:2048
    ds_write_b128 v12, v[44:47] offset:3072
    v_lshlrev_b32 v108, 16, v248
    v_and_b32 v109, 0xffff0000, v248
    v_lshlrev_b32 v110, 16, v249
    v_and_b32 v111, 0xffff0000, v249
    v_lshlrev_b32 v112, 16, v250
    v_and_b32 v113, 0xffff0000, v250
    v_lshlrev_b32 v114, 16, v251
    v_and_b32 v115, 0xffff0000, v251
    v_lshlrev_b32 v116, 16, v252
    v_and_b32 v117, 0xffff0000, v252
    v_lshlrev_b32 v118, 16, v253
    v_and_b32 v119, 0xffff0000, v253
    v_lshlrev_b32 v120, 16, v254
    v_and_b32 v121, 0xffff0000, v254
    v_lshlrev_b32 v122, 16, v255
    v_and_b32 v123, 0xffff0000, v255
    s_waitcnt lgkmcnt(0)
    s_barrier
    ds_read_b128 v[92:95], v13 offset:0
    ds_read_b128 v[96:99], v13 offset:1024
    ds_read_b128 v[100:103], v13 offset:2048
    ds_read_b128 v[104:107], v13 offset:3072
    v_pk_add_f32 v[16:17], v[16:17], v[108:109]
    v_pk_add_f32 v[18:19], v[18:19], v[110:111]
    v_pk_add_f32 v[20:21], v[20:21], v[112:113]
    v_pk_add_f32 v[22:23], v[22:23], v[114:115]
    v_pk_add_f32 v[24:25], v[24:25], v[116:117]
    v_pk_add_f32 v[26:27], v[26:27], v[118:119]
    v_pk_add_f32 v[28:29], v[28:29], v[120:121]
    v_pk_add_f32 v[30:31], v[30:31], v[122:123]
    v_lshlrev_b32 v5, 10, v3
    v_lshl_add_u32 v5, v4, 4, v5
    s_lshl_b32 s52, s49, 15
    s_lshl_b32 s53, s48, 7
    s_add_u32 s52, s52, s53
    s_lshl_b32 s53, s46, 6
    s_add_u32 s52, s52, s53
    v_sub_f32 v72, 1.0, v74
    v_sub_f32 v73, 1.0, v74
    v_mov_b32 v75, v74
    s_waitcnt lgkmcnt(0)
    v_pk_add_f32 v[16:17], v[16:17], v[92:93]
    v_pk_add_f32 v[18:19], v[18:19], v[94:95]
    v_pk_add_f32 v[20:21], v[20:21], v[96:97]
    v_pk_add_f32 v[22:23], v[22:23], v[98:99]
    v_pk_add_f32 v[24:25], v[24:25], v[100:101]
    v_pk_add_f32 v[26:27], v[26:27], v[102:103]
    v_pk_add_f32 v[28:29], v[28:29], v[104:105]
    v_pk_add_f32 v[30:31], v[30:31], v[106:107]
    v_pk_mul_f32 v[16:17], v[16:17], v[72:73]
    v_pk_mul_f32 v[18:19], v[18:19], v[72:73]
    v_pk_mul_f32 v[20:21], v[20:21], v[72:73]
    v_pk_mul_f32 v[22:23], v[22:23], v[72:73]
    v_pk_mul_f32 v[24:25], v[24:25], v[72:73]
    v_pk_mul_f32 v[26:27], v[26:27], v[72:73]
    v_pk_mul_f32 v[28:29], v[28:29], v[72:73]
    v_pk_mul_f32 v[30:31], v[30:31], v[72:73]
    s_waitcnt vmcnt(0)
    v_lshlrev_b32 v108, 16, v76
    v_and_b32 v109, 0xffff0000, v76
    v_lshlrev_b32 v110, 16, v77
    v_and_b32 v111, 0xffff0000, v77
    v_lshlrev_b32 v112, 16, v78
    v_and_b32 v113, 0xffff0000, v78
    v_lshlrev_b32 v114, 16, v79
    v_and_b32 v115, 0xffff0000, v79
    v_lshlrev_b32 v116, 16, v80
    v_and_b32 v117, 0xffff0000, v80
    v_lshlrev_b32 v118, 16, v81
    v_and_b32 v119, 0xffff0000, v81
    v_lshlrev_b32 v120, 16, v82
    v_and_b32 v121, 0xffff0000, v82
    v_lshlrev_b32 v122, 16, v83
    v_and_b32 v123, 0xffff0000, v83
    v_pk_fma_f32 v[16:17], v[108:109], v[74:75], v[16:17]
    v_pk_fma_f32 v[18:19], v[110:111], v[74:75], v[18:19]
    v_pk_fma_f32 v[20:21], v[112:113], v[74:75], v[20:21]
    v_pk_fma_f32 v[22:23], v[114:115], v[74:75], v[22:23]
    v_pk_fma_f32 v[24:25], v[116:117], v[74:75], v[24:25]
    v_pk_fma_f32 v[26:27], v[118:119], v[74:75], v[26:27]
    v_pk_fma_f32 v[28:29], v[120:121], v[74:75], v[28:29]
    v_pk_fma_f32 v[30:31], v[122:123], v[74:75], v[30:31]
    v_cvt_pk_bf16_f32 v92, v16, v17
    v_cvt_pk_bf16_f32 v93, v18, v19
    v_cvt_pk_bf16_f32 v94, v20, v21
    v_cvt_pk_bf16_f32 v95, v22, v23
    v_cvt_pk_bf16_f32 v96, v24, v25
    v_cvt_pk_bf16_f32 v97, v26, v27
    v_cvt_pk_bf16_f32 v98, v28, v29
    v_cvt_pk_bf16_f32 v99, v30, v31
    v_permlane32_swap_b32 v92, v94
    v_permlane32_swap_b32 v93, v95
    v_permlane32_swap_b32 v96, v98
    v_permlane32_swap_b32 v97, v99
    buffer_store_dwordx4 v[92:95], v5, s[40:43], s52 offen
    buffer_store_dwordx4 v[96:99], v5, s[40:43], s52 offen offset:32
    s_endpgm
L_G0:
    s_mov_b64 s[28:29], s[26:27]
    s_mov_b32 s30, 21233664
    s_mov_b32 s31, 0x20000
    s_or_b32 s52, s50, s51
    s_or_b32 s52, s52, s44
    s_cmp_lg_u32 s52, 0
    s_cbranch_scc1 non_53
    s_mov_b32 s52, 20836352
    buffer_load_dword v24, off, s[28:31], s52 sc1
    s_mov_b32 s53, 1664525
    s_waitcnt vmcnt(0)
    v_mul_lo_u32 v252, v24, s53
    v_add_u32 v252, 1013904223, v252
    v_max_u32 v252, 1, v252
    v_mov_b32 v253, 0
    s_mov_b64 exec, 1
    global_store_dword v253, v252, s[24:25] sc1
    buffer_store_dword v252, off, s[28:31], s52 sc1
    s_mov_b64 exec, -1
non_53:
    s_mov_b64 s[36:37], s[4:5]
    s_mov_b32 s38, 2097152
    s_mov_b32 s39, 0x20000
    s_mov_b64 s[40:41], s[20:21]
    s_mov_b32 s42, 1024
    s_mov_b32 s43, 0x20000
    v_lshlrev_b32 v5, 4, v3
    v_lshl_add_u32 v9, v4, 10, v5
    s_lshl_b32 s58, s50, 5
    s_add_u32 s58, s58, s51
    s_lshl_b32 s58, s58, 2
    s_add_u32 s58, s58, s44
    s_lshl_b32 s52, s58, 11
    buffer_load_dwordx4 v[224:227], v9, s[36:39], s52 offen
    buffer_load_dwordx4 v[228:231], v9, s[36:39], s52 offen offset:512
    buffer_load_dwordx4 v[232:235], v5, s[40:43], 0 offen
    buffer_load_dwordx4 v[236:239], v5, s[40:43], 0 offen offset:512
    s_mov_b64 s[32:33], s[6:7]
    s_mov_b32 s34, 1572864
    s_mov_b32 s35, 0x20000
    s_mul_i32 s52, s58, 1536
    v_min_u32 v5, 11, v1
    v_lshlrev_b32 v5, 7, v5
    buffer_load_dword v250, v5, s[32:35], s52 offen
    s_mov_b64 s[32:33], s[12:13]
    s_mov_b32 s34, 524288
    s_mov_b32 s35, 0x20000
    s_mul_i32 s52, s58, 512
    v_min_u32 v5, 3, v1
    v_lshlrev_b32 v5, 7, v5
    buffer_load_dword v250, v5, s[32:35], s52 offen
    s_mov_b64 s[32:33], s[14:15]
    s_mov_b32 s34, 524288
    s_mov_b32 s35, 0x20000
    s_lshl_b32 s52, s51, 2
    s_add_u32 s52, s52, s44
    s_mul_i32 s52, s52, 4096
    v_min_u32 v5, 3, v1
    v_lshlrev_b32 v5, 10, v5
    buffer_load_dword v250, v5, s[32:35], s52 offen offset:384
    s_mov_b64 s[32:33], s[14:15]
    s_mov_b32 s34, 524288
    s_mov_b32 s35, 0x20000
    s_lshl_b32 s52, s50, 5
    s_add_u32 s52, s52, s51
    s_lshl_b32 s52, s52, 2
    s_add_u32 s52, s52, s44
    s_mul_i32 s52, s52, 512
    v_min_u32 v5, 3, v1
    v_lshlrev_b32 v5, 7, v5
    buffer_load_dword v250, v5, s[32:35], s52 offen
    v_lshlrev_b32 v5, 2, v1
    v_add_u32 v5, 159744, v5
    v_mov_b32 v23, 0
    ds_write_b32 v5, v23
    s_lshl_b32 s53, s44, 5
    v_bfe_u32 v5, v3, 1, 3
    v_xor_b32 v5, v5, v4
    v_lshlrev_b32 v5, 4, v5
    v_lshl_add_u32 v5, v3, 7, v5
    s_lshl_b32 s52, s53, 7
    v_add_u32 v16, s52, v5
    v_xor_b32 v17, 32, v16
    v_xor_b32 v18, 64, v16
    v_xor_b32 v19, 96, v16
    v_bfe_u32 v5, v1, 2, 2
    v_lshlrev_b32 v20, 3, v4
    v_add_u32 v20, v20, v5
    v_lshlrev_b32 v20, 7, v20
    v_lshrrev_b32 v5, 1, v5
    v_lshl_add_u32 v20, v5, 6, v20
    v_bfe_u32 v5, v1, 4, 1
    v_lshl_add_u32 v20, v5, 5, v20
    v_and_b32 v5, 3, v1
    v_lshl_add_u32 v20, v5, 3, v20
    v_add_u32 v20, 16384, v20
    v_xor_b32 v21, 64, v20
    v_mov_b32 v24, 0x3f803f80
    v_mov_b32 v25, 0x3f803f80
    v_mov_b32 v26, 0x3f803f80
    v_mov_b32 v27, 0x3f803f80
    s_lshl_b32 s73, s97, 2
    s_add_u32 s73, s73, s44
    s_and_b32 s53, s96, 7
    s_and_b32 s54, s96, 8
    s_add_u32 s54, s54, s96
    s_lshl_b32 s72, s54, 2
    s_lshl_b32 s55, s73, 7
    s_add_u32 s72, s72, s55
    s_add_u32 s72, s72, 20799488
    s_add_u32 s98, s72, 32
    s_xor_b32 s72, s72, 4
    s_xor_b32 s98, s98, 16
    s_sub_u32 s74, s72, 20799488
    s_lshl_b32 s74, s74, 5
    s_add_u32 s74, s74, 20971520
    s_sub_u32 s75, s98, 20799488
    s_lshl_b32 s75, s75, 5
    s_add_u32 s75, s75, 20971520
    s_lshl_b32 s68, s96, 18
    s_lshl_b32 s55, s73, 10
    s_add_u32 s68, s68, s55
    s_lshl_b32 s70, s73, 15
    s_lshl_b32 s53, s53, 12
    s_add_u32 s70, s70, s53
    s_add_u32 s70, s70, 6291456
    s_add_u32 s52, s68, 2097152
    s_xor_b32 s52, s52, 1048576
    s_xor_b32 s70, s70, 16384
    s_xor_b32 s68, s68, 262144
    s_cmp_lt_u32 s96, 8
    s_cselect_b32 s70, s70, s52
    s_add_u32 s69, s68, 131072
    s_add_u32 s71, s70, 131072
    v_add_u32 v9, 65536, v2
    v_bfe_u32 v6, v1, 4, 1
    v_lshlrev_b32 v6, 16, v6
    v_lshl_add_u32 v6, v4, 8, v6
    v_and_b32 v5, 15, v1
    v_lshl_add_u32 v6, v5, 4, v6
    s_lshl_b32 s56, s44, 12
    s_add_u32 s56, s56, 143360
    s_xor_b32 s57, s44, 2
    s_lshl_b32 s57, s57, 12
    s_add_u32 s57, s57, 143360
    s_lshl_b32 s52, s49, 5
    s_add_u32 s53, s46, 1
    v_add_u32 v5, s52, v3
    v_subrev_u32 v10, s53, v5
    v_lshrrev_b32 v12, 5, v10
    v_lshlrev_b32 v12, 15, v12
    v_and_b32 v11, 31, v10
    v_lshl_add_u32 v12, v11, 4, v12
    v_lshl_add_u32 v12, v4, 9, v12
    v_mov_b32 v11, 0x40000000
    v_cmp_gt_u32 vcc, 2048, v10
    s_nop 1
    v_cndmask_b32 v12, v11, v12, vcc
    v_add_u32 v10, s53, v5
    v_lshrrev_b32 v13, 5, v10
    v_lshlrev_b32 v13, 15, v13
    v_and_b32 v11, 31, v10
    v_lshl_add_u32 v13, v11, 4, v13
    v_lshl_add_u32 v13, v4, 9, v13
    v_mov_b32 v11, 0x40000000
    v_cmp_gt_u32 vcc, 2048, v10
    s_nop 1
    v_cndmask_b32 v13, v11, v13, vcc
    v_bfe_u32 v10, v1, 2, 2
    v_lshlrev_b32 v7, 2, v4
    v_add_u32 v7, v7, v10
    v_lshlrev_b32 v7, 7, v7
    v_lshrrev_b32 v10, 1, v10
    v_xor_b32 v10, s46, v10
    v_lshl_add_u32 v7, v10, 6, v7
    v_bfe_u32 v10, v1, 4, 1
    v_lshl_add_u32 v7, v10, 5, v7
    v_and_b32 v10, 3, v1
    v_lshl_add_u32 v7, v10, 3, v7
    s_lshl_b32 s52, s46, 15
    s_add_u32 s52, s52, 28672
    v_add_u32 v7, s52, v7
    v_xor_b32 v8, 64, v7
    v_lshrrev_b32 v5, 2, v1
    v_min_u32 v5, 2, v5
    s_sub_u32 s52, s49, 1
    v_add_u32 v5, s52, v5
    v_max_i32 v5, 0, v5
    v_min_i32 v5, 63, v5
    v_and_b32 v14, 3, v1
    v_lshlrev_b32 v14, 2, v14
    v_lshl_add_u32 v14, v5, 7, v14
    s_lshl_b32 s52, s46, 4
    s_add_u32 s52, s52, 32
    v_add_u32 v14, s52, v14
    s_and_b32 s52, s49, 3
    s_lshl_b32 s52, s52, 12
    s_lshl_b32 s53, s46, 2
    v_bfe_u32 v5, v3, 1, 3
    v_xor_b32 v5, s53, v5
    v_lshlrev_b32 v5, 4, v5
    v_lshl_add_u32 v5, v3, 7, v5
    v_lshl_add_u32 v5, v4, 3, v5
    s_mul_i32 s53, s48, 43
    s_lshr_b32 s53, s53, 7
    s_mul_i32 s53, s53, 3
    s_sub_u32 s53, s48, s53
    s_mul_i32 s53, s53, 24576
    s_add_u32 s52, s52, s53
    v_add_u32 v5, s52, v5
    v_xor_b32 v56, 0, v5
    v_xor_b32 v58, 16, v5
    v_xor_b32 v60, 32, v5
    v_xor_b32 v62, 48, v5
    s_waitcnt lgkmcnt(0)
    s_barrier
    ds_read_b128 v[128:131], v16 offset:0
    ds_read_b64_tr_b16 v[32:33], v20 offset:0
    ds_read_b64_tr_b16 v[34:35], v20 offset:512
    ds_read_b64_tr_b16 v[36:37], v21 offset:0
    ds_read_b64_tr_b16 v[38:39], v21 offset:512
    ds_read_b128 v[132:135], v17 offset:0
    ds_read_b64_tr_b16 v[40:41], v20 offset:2048
    ds_read_b64_tr_b16 v[42:43], v20 offset:2560
    ds_read_b64_tr_b16 v[44:45], v21 offset:2048
    ds_read_b64_tr_b16 v[46:47], v21 offset:2560
    s_waitcnt lgkmcnt(5)
    v_mfma_f32_32x32x16_bf16 v[64:79], v[32:35], v[128:131], 0
    ds_read_b128 v[136:139], v18 offset:0
    ds_read_b64_tr_b16 v[48:49], v20 offset:4096
    ds_read_b64_tr_b16 v[50:51], v20 offset:4608
    v_mfma_f32_32x32x16_bf16 v[80:95], v[36:39], v[128:131], 0
    ds_read_b64_tr_b16 v[52:53], v21 offset:4096
    ds_read_b64_tr_b16 v[54:55], v21 offset:4608
    s_waitcnt lgkmcnt(5)
    v_mfma_f32_32x32x16_bf16 v[64:79], v[40:43], v[132:135], v[64:79]
    ds_read_b128 v[140:143], v19 offset:0
    ds_read_b64_tr_b16 v[32:33], v20 offset:6144
    ds_read_b64_tr_b16 v[34:35], v20 offset:6656
    v_mfma_f32_32x32x16_bf16 v[80:95], v[44:47], v[132:135], v[80:95]
    ds_read_b64_tr_b16 v[36:37], v21 offset:6144
    ds_read_b64_tr_b16 v[38:39], v21 offset:6656
    s_waitcnt lgkmcnt(5)
    v_mfma_f32_32x32x16_bf16 v[64:79], v[48:51], v[136:139], v[64:79]
    s_cmp_eq_u32 s48, 0
    s_cbranch_scc1 xr_54_s
xr_54:
    s_waitcnt lgkmcnt(0)
    s_barrier
    ds_read_b128 v[144:147], v16 offset:24576
    ds_read_b64_tr_b16 v[40:41], v20 offset:24576
    ds_read_b64_tr_b16 v[42:43], v20 offset:25088
    v_mfma_f32_32x32x16_bf16 v[80:95], v[52:55], v[136:139], v[80:95]
    ds_read_b64_tr_b16 v[44:45], v21 offset:24576
    ds_read_b64_tr_b16 v[46:47], v21 offset:25088
    v_mfma_f32_32x32x16_bf16 v[64:79], v[32:35], v[140:143], v[64:79]
    ds_read_b128 v[148:151], v17 offset:24576
    ds_read_b64_tr_b16 v[48:49], v20 offset:26624
    ds_read_b64_tr_b16 v[50:51], v20 offset:27136
    v_mfma_f32_32x32x16_bf16 v[80:95], v[36:39], v[140:143], v[80:95]
    ds_read_b64_tr_b16 v[52:53], v21 offset:26624
    ds_read_b64_tr_b16 v[54:55], v21 offset:27136
    s_waitcnt lgkmcnt(5)
    v_mfma_f32_32x32x16_bf16 v[64:79], v[40:43], v[144:147], v[64:79]
    ds_read_b128 v[152:155], v18 offset:24576
    ds_read_b64_tr_b16 v[32:33], v20 offset:28672
    ds_read_b64_tr_b16 v[34:35], v20 offset:29184
    v_mfma_f32_32x32x16_bf16 v[80:95], v[44:47], v[144:147], v[80:95]
    ds_read_b64_tr_b16 v[36:37], v21 offset:28672
    ds_read_b64_tr_b16 v[38:39], v21 offset:29184
    global_load_dword v22, v23, s[24:25] sc1
    s_waitcnt lgkmcnt(5)
    v_mfma_f32_32x32x16_bf16 v[64:79], v[48:51], v[148:151], v[64:79]
    ds_read_b128 v[156:159], v19 offset:24576
    ds_read_b64_tr_b16 v[40:41], v20 offset:30720
    ds_read_b64_tr_b16 v[42:43], v20 offset:31232
    v_mfma_f32_32x32x16_bf16 v[80:95], v[52:55], v[148:151], v[80:95]
    ds_read_b64_tr_b16 v[44:45], v21 offset:30720
    ds_read_b64_tr_b16 v[46:47], v21 offset:31232
    s_waitcnt lgkmcnt(5)
    v_mfma_f32_32x32x16_bf16 v[64:79], v[32:35], v[152:155], v[64:79]
    s_cmp_eq_u32 s48, 1
    s_cbranch_scc1 xr_55_s
xr_55:
    s_waitcnt lgkmcnt(0)
    s_barrier
    ds_read_b128 v[160:163], v16 offset:49152
    ds_read_b64_tr_b16 v[48:49], v20 offset:49152
    ds_read_b64_tr_b16 v[50:51], v20 offset:49664
    v_mfma_f32_32x32x16_bf16 v[80:95], v[36:39], v[152:155], v[80:95]
    ds_read_b64_tr_b16 v[52:53], v21 offset:49152
    ds_read_b64_tr_b16 v[54:55], v21 offset:49664
    v_mfma_f32_32x32x16_bf16 v[64:79], v[40:43], v[156:159], v[64:79]
    ds_read_b128 v[164:167], v17 offset:49152
    ds_read_b64_tr_b16 v[32:33], v20 offset:51200
    ds_read_b64_tr_b16 v[34:35], v20 offset:51712
    v_mfma_f32_32x32x16_bf16 v[80:95], v[44:47], v[156:159], v[80:95]
    ds_read_b64_tr_b16 v[36:37], v21 offset:51200
    ds_read_b64_tr_b16 v[38:39], v21 offset:51712
    s_waitcnt lgkmcnt(5)
    v_mfma_f32_32x32x16_bf16 v[64:79], v[48:51], v[160:163], v[64:79]
    ds_read_b128 v[168:171], v18 offset:49152
    ds_read_b64_tr_b16 v[40:41], v20 offset:53248
    ds_read_b64_tr_b16 v[42:43], v20 offset:53760
    v_mfma_f32_32x32x16_bf16 v[80:95], v[52:55], v[160:163], v[80:95]
    ds_read_b64_tr_b16 v[44:45], v21 offset:53248
    ds_read_b64_tr_b16 v[46:47], v21 offset:53760
    s_waitcnt lgkmcnt(5)
    v_mfma_f32_32x32x16_bf16 v[64:79], v[32:35], v[164:167], v[64:79]
    ds_read_b128 v[172:175], v19 offset:49152
    ds_read_b64_tr_b16 v[48:49], v20 offset:55296
    ds_read_b64_tr_b16 v[50:51], v20 offset:55808
    v_mfma_f32_32x32x16_bf16 v[80:95], v[36:39], v[164:167], v[80:95]
    ds_read_b64_tr_b16 v[52:53], v21 offset:55296
    ds_read_b64_tr_b16 v[54:55], v21 offset:55808
    s_waitcnt lgkmcnt(5)
    v_mfma_f32_32x32x16_bf16 v[64:79], v[40:43], v[168:171], v[64:79]
    s_cmp_eq_u32 s48, 2
    s_cbranch_scc1 xr_56_s
xr_56:
    s_waitcnt lgkmcnt(0)
    s_barrier
    ds_read_b128 v[176:179], v16 offset:0
    ds_read_b64_tr_b16 v[32:33], v20 offset:0
    ds_read_b64_tr_b16 v[34:35], v20 offset:512
    v_mfma_f32_32x32x16_bf16 v[80:95], v[44:47], v[168:171], v[80:95]
    ds_read_b64_tr_b16 v[36:37], v21 offset:0
    ds_read_b64_tr_b16 v[38:39], v21 offset:512
    v_mfma_f32_32x32x16_bf16 v[64:79], v[48:51], v[172:175], v[64:79]
    ds_read_b128 v[180:183], v17 offset:0
    ds_read_b64_tr_b16 v[40:41], v20 offset:2048
    ds_read_b64_tr_b16 v[42:43], v20 offset:2560
    v_mfma_f32_32x32x16_bf16 v[80:95], v[52:55], v[172:175], v[80:95]
    ds_read_b64_tr_b16 v[44:45], v21 offset:2048
    ds_read_b64_tr_b16 v[46:47], v21 offset:2560
    s_waitcnt lgkmcnt(5)
    v_mfma_f32_32x32x16_bf16 v[64:79], v[32:35], v[176:179], v[64:79]
    ds_read_b128 v[184:187], v18 offset:0
    ds_read_b64_tr_b16 v[48:49], v20 offset:4096
    ds_read_b64_tr_b16 v[50:51], v20 offset:4608
    v_mfma_f32_32x32x16_bf16 v[80:95], v[36:39], v[176:179], v[80:95]
    ds_read_b64_tr_b16 v[52:53], v21 offset:4096
    ds_read_b64_tr_b16 v[54:55], v21 offset:4608
    v_mov_b32 v240, 0
    v_mov_b32 v241, 0
    v_mov_b32 v242, 0
    s_waitcnt vmcnt(0)
    v_dot2_f32_bf16 v240, v224, v24, v240
    v_dot2_f32_bf16 v241, v224, v224, v241
    v_dot2_f32_bf16 v242, v224, v232, v242
    v_dot2_f32_bf16 v240, v225, v24, v240
    v_dot2_f32_bf16 v241, v225, v225, v241
    v_dot2_f32_bf16 v242, v225, v233, v242
    v_dot2_f32_bf16 v240, v226, v24, v240
    v_dot2_f32_bf16 v241, v226, v226, v241
    v_dot2_f32_bf16 v242, v226, v234, v242
    v_dot2_f32_bf16 v240, v227, v24, v240
    v_dot2_f32_bf16 v241, v227, v227, v241
    v_dot2_f32_bf16 v242, v227, v235, v242
    v_dot2_f32_bf16 v240, v228, v24, v240
    v_dot2_f32_bf16 v241, v228, v228, v241
    v_dot2_f32_bf16 v242, v228, v236, v242
    v_dot2_f32_bf16 v240, v229, v24, v240
    v_dot2_f32_bf16 v241, v229, v229, v241
    v_dot2_f32_bf16 v242, v229, v237, v242
    v_dot2_f32_bf16 v240, v230, v24, v240
    v_dot2_f32_bf16 v241, v230, v230, v241
    v_dot2_f32_bf16 v242, v230, v238, v242
    v_dot2_f32_bf16 v240, v231, v24, v240
    v_dot2_f32_bf16 v241, v231, v231, v241
    v_dot2_f32_bf16 v242, v231, v239, v242
    s_nop 0
    v_add_f32_dpp v240, v240, v240 quad_perm:[1,0,3,2] row_mask:0xf bank_mask:0xf
    v_add_f32_dpp v241, v241, v241 quad_perm:[1,0,3,2] row_mask:0xf bank_mask:0xf
    v_add_f32_dpp v242, v242, v242 quad_perm:[1,0,3,2] row_mask:0xf bank_mask:0xf
    v_add_f32_dpp v240, v240, v240 quad_perm:[2,3,0,1] row_mask:0xf bank_mask:0xf
    v_add_f32_dpp v241, v241, v241 quad_perm:[2,3,0,1] row_mask:0xf bank_mask:0xf
    v_add_f32_dpp v242, v242, v242 quad_perm:[2,3,0,1] row_mask:0xf bank_mask:0xf
    v_add_f32_dpp v240, v240, v240 row_half_mirror row_mask:0xf bank_mask:0xf
    v_add_f32_dpp v241, v241, v241 row_half_mirror row_mask:0xf bank_mask:0xf
    v_add_f32_dpp v242, v242, v242 row_half_mirror row_mask:0xf bank_mask:0xf
    v_add_f32_dpp v240, v240, v240 row_mirror row_mask:0xf bank_mask:0xf
    v_add_f32_dpp v241, v241, v241 row_mirror row_mask:0xf bank_mask:0xf
    v_add_f32_dpp v242, v242, v242 row_mirror row_mask:0xf bank_mask:0xf
    v_mov_b32 v244, v240
    v_mov_b32 v245, v241
    v_mov_b32 v246, v242
    v_permlane16_swap_b32 v240, v244
    v_permlane16_swap_b32 v241, v245
    v_permlane16_swap_b32 v242, v246
    v_add_f32 v240, v240, v244
    v_add_f32 v241, v241, v245
    v_add_f32 v242, v242, v246
    v_mul_f32 v240, 0x3b000000, v240
    v_mul_f32 v241, 0x3b000000, v241
    v_fma_f32 v241, -v240, v240, v241
    v_max_f32 v241, 0, v241
    v_add_f32 v241, 0x3727c5ac, v241
    v_rsq_f32 v241, v241
    v_mul_f32 v242, 0xbfb8aa3b, v242
    v_exp_f32 v242, v242
    s_nop 0
    v_add_f32 v242, 1.0, v242
    v_rcp_f32 v242, v242
    v_readfirstlane_b32 s3, v22
    s_nop 0
    s_cmp_lg_u32 s3, 0
    s_cbranch_scc1 non_ok_57
    v_mov_b32 v23, 0
    s_mov_b32 s10, 0x20000
nonce_58:
    global_load_dword v22, v23, s[24:25] sc1
    s_waitcnt vmcnt(0)
    v_readfirstlane_b32 s3, v22
    s_nop 0
    s_cmp_lg_u32 s3, 0
    s_cbranch_scc1 nonce_done_59
    s_sub_u32 s10, s10, 1
    s_cbranch_scc0 nonce_58
nonce_done_59:
non_ok_57:
    v_mov_b32 v243, s3
    s_lshl_b32 s52, s58, 5
    s_add_u32 s52, s52, 20578304
    v_lshlrev_b32 v5, 4, v4
    v_mov_b32 v10, 159872
    s_mov_b32 exec_lo, 1
    s_mov_b32 exec_hi, 1
    buffer_store_dwordx4 v[240:243], v5, s[28:31], s52 offen sc1
    ds_write_b32 v10, v243
    s_mov_b64 exec, 1
    s_getreg_b32 s76, hwreg(HW_REG_XCC_ID, 0, 4)
    s_add_u32 s76, s76, s3
    v_mov_b32 v244, s76
    s_lshl_b32 s52, s50, 7
    s_lshl_b32 s53, s51, 2
    s_add_u32 s52, s52, s53
    s_add_u32 s52, s52, 20832256
    s_cmp_eq_u32 s44, 0
    s_cselect_b32 s52, s52, 0x40000000
    buffer_store_dword v244, off, s[28:31], s52
    s_mov_b64 exec, -1
    s_waitcnt lgkmcnt(6)
    v_mfma_f32_32x32x16_bf16 v[64:79], v[40:43], v[180:183], v[64:79]
    ds_read_b128 v[188:191], v19 offset:0
    ds_read_b64_tr_b16 v[32:33], v20 offset:6144
    ds_read_b64_tr_b16 v[34:35], v20 offset:6656
    v_mfma_f32_32x32x16_bf16 v[80:95], v[44:47], v[180:183], v[80:95]
    ds_read_b64_tr_b16 v[36:37], v21 offset:6144
    ds_read_b64_tr_b16 v[38:39], v21 offset:6656
    s_waitcnt lgkmcnt(6)
    v_mfma_f32_32x32x16_bf16 v[64:79], v[48:51], v[184:187], v[64:79]
    s_cmp_eq_u32 s48, 3
    s_cbranch_scc1 xr_60_s
xr_60:
    s_waitcnt lgkmcnt(0)
    s_barrier
    ds_read_b128 v[192:195], v16 offset:24576
    ds_read_b64_tr_b16 v[40:41], v20 offset:24576
    ds_read_b64_tr_b16 v[42:43], v20 offset:25088
    v_mfma_f32_32x32x16_bf16 v[80:95], v[52:55], v[184:187], v[80:95]
    ds_read_b64_tr_b16 v[44:45], v21 offset:24576
    ds_read_b64_tr_b16 v[46:47], v21 offset:25088
    v_mfma_f32_32x32x16_bf16 v[64:79], v[32:35], v[188:191], v[64:79]
    ds_read_b128 v[196:199], v17 offset:24576
    ds_read_b64_tr_b16 v[48:49], v20 offset:26624
    ds_read_b64_tr_b16 v[50:51], v20 offset:27136
    v_mfma_f32_32x32x16_bf16 v[80:95], v[36:39], v[188:191], v[80:95]
    ds_read_b64_tr_b16 v[52:53], v21 offset:26624
    ds_read_b64_tr_b16 v[54:55], v21 offset:27136
    s_waitcnt lgkmcnt(5)
    v_mfma_f32_32x32x16_bf16 v[64:79], v[40:43], v[192:195], v[64:79]
    ds_read_b128 v[200:203], v18 offset:24576
    ds_read_b64_tr_b16 v[32:33], v20 offset:28672
    ds_read_b64_tr_b16 v[34:35], v20 offset:29184
    v_mfma_f32_32x32x16_bf16 v[80:95], v[44:47], v[192:195], v[80:95]
    ds_read_b64_tr_b16 v[36:37], v21 offset:28672
    ds_read_b64_tr_b16 v[38:39], v21 offset:29184
    s_waitcnt lgkmcnt(5)
    v_mfma_f32_32x32x16_bf16 v[64:79], v[48:51], v[196:199], v[64:79]
    ds_read_b128 v[204:207], v19 offset:24576
    ds_read_b64_tr_b16 v[40:41], v20 offset:30720
    ds_read_b64_tr_b16 v[42:43], v20 offset:31232
    v_mfma_f32_32x32x16_bf16 v[80:95], v[52:55], v[196:199], v[80:95]
    ds_read_b64_tr_b16 v[44:45], v21 offset:30720
    ds_read_b64_tr_b16 v[46:47], v21 offset:31232
    s_waitcnt lgkmcnt(5)
    v_mfma_f32_32x32x16_bf16 v[64:79], v[32:35], v[200:203], v[64:79]
    s_cmp_eq_u32 s48, 4
    s_cbranch_scc1 xr_61_s
xr_61:
    s_waitcnt lgkmcnt(0)
    s_barrier
    ds_read_b128 v[208:211], v16 offset:49152
    ds_read_b64_tr_b16 v[48:49], v20 offset:49152
    ds_read_b64_tr_b16 v[50:51], v20 offset:49664
    v_mfma_f32_32x32x16_bf16 v[80:95], v[36:39], v[200:203], v[80:95]
    ds_read_b64_tr_b16 v[52:53], v21 offset:49152
    ds_read_b64_tr_b16 v[54:55], v21 offset:49664
    v_mfma_f32_32x32x16_bf16 v[64:79], v[40:43], v[204:207], v[64:79]
    ds_read_b128 v[212:215], v17 offset:49152
    ds_read_b64_tr_b16 v[32:33], v20 offset:51200
    ds_read_b64_tr_b16 v[34:35], v20 offset:51712
    v_mfma_f32_32x32x16_bf16 v[80:95], v[44:47], v[204:207], v[80:95]
    ds_read_b64_tr_b16 v[36:37], v21 offset:51200
    ds_read_b64_tr_b16 v[38:39], v21 offset:51712
    s_waitcnt lgkmcnt(5)
    v_mfma_f32_32x32x16_bf16 v[64:79], v[48:51], v[208:211], v[64:79]
    ds_read_b128 v[216:219], v18 offset:49152
    ds_read_b64_tr_b16 v[40:41], v20 offset:53248
    ds_read_b64_tr_b16 v[42:43], v20 offset:53760
    v_mfma_f32_32x32x16_bf16 v[80:95], v[52:55], v[208:211], v[80:95]
    ds_read_b64_tr_b16 v[44:45], v21 offset:53248
    ds_read_b64_tr_b16 v[46:47], v21 offset:53760
    s_waitcnt lgkmcnt(5)
    v_mfma_f32_32x32x16_bf16 v[64:79], v[32:35], v[212:215], v[64:79]
    ds_read_b128 v[220:223], v19 offset:49152
    ds_read_b64_tr_b16 v[48:49], v20 offset:55296
    ds_read_b64_tr_b16 v[50:51], v20 offset:55808
    v_mfma_f32_32x32x16_bf16 v[80:95], v[36:39], v[212:215], v[80:95]
    ds_read_b64_tr_b16 v[52:53], v21 offset:55296
    ds_read_b64_tr_b16 v[54:55], v21 offset:55808
    s_waitcnt lgkmcnt(5)
    v_mfma_f32_32x32x16_bf16 v[64:79], v[40:43], v[216:219], v[64:79]
    s_cmp_eq_u32 s48, 5
    s_cbranch_scc1 xr_62_s
xr_62:
    s_waitcnt lgkmcnt(0)
    s_barrier
    ds_read_b128 v[224:227], v16 offset:0
    ds_read_b64_tr_b16 v[32:33], v20 offset:0
    ds_read_b64_tr_b16 v[34:35], v20 offset:512
    v_mfma_f32_32x32x16_bf16 v[80:95], v[44:47], v[216:219], v[80:95]
    ds_read_b64_tr_b16 v[36:37], v21 offset:0
    ds_read_b64_tr_b16 v[38:39], v21 offset:512
    v_mfma_f32_32x32x16_bf16 v[64:79], v[48:51], v[220:223], v[64:79]
    ds_read_b128 v[228:231], v17 offset:0
    ds_read_b64_tr_b16 v[40:41], v20 offset:2048
    ds_read_b64_tr_b16 v[42:43], v20 offset:2560
    v_mfma_f32_32x32x16_bf16 v[80:95], v[52:55], v[220:223], v[80:95]
    ds_read_b64_tr_b16 v[44:45], v21 offset:2048
    ds_read_b64_tr_b16 v[46:47], v21 offset:2560
    s_waitcnt lgkmcnt(5)
    v_mfma_f32_32x32x16_bf16 v[64:79], v[32:35], v[224:227], v[64:79]
    ds_read_b128 v[232:235], v18 offset:0
    ds_read_b64_tr_b16 v[48:49], v20 offset:4096
    ds_read_b64_tr_b16 v[50:51], v20 offset:4608
    v_mfma_f32_32x32x16_bf16 v[80:95], v[36:39], v[224:227], v[80:95]
    ds_read_b64_tr_b16 v[52:53], v21 offset:4096
    ds_read_b64_tr_b16 v[54:55], v21 offset:4608
    v_lshlrev_b32 v5, 4, v3
    s_lshl_b32 s52, s73, 9
    s_add_u32 s52, s52, 20578304
    s_cmp_ge_u32 s96, 8
    s_cselect_b32 s52, 0x40000000, s52
    buffer_load_dwordx4 v[28:31], v5, s[28:31], s52 offen sc1
    v_lshlrev_b32 v5, 2, v3
    s_lshl_b32 s52, s50, 7
    s_add_u32 s52, s52, 20832256
    buffer_load_dword v22, v5, s[28:31], s52 offen sc1
    s_waitcnt lgkmcnt(5)
    v_mfma_f32_32x32x16_bf16 v[64:79], v[40:43], v[228:231], v[64:79]
    ds_read_b128 v[236:239], v19 offset:0
    ds_read_b64_tr_b16 v[32:33], v20 offset:6144
    ds_read_b64_tr_b16 v[34:35], v20 offset:6656
    v_mfma_f32_32x32x16_bf16 v[80:95], v[44:47], v[228:231], v[80:95]
    ds_read_b64_tr_b16 v[36:37], v21 offset:6144
    ds_read_b64_tr_b16 v[38:39], v21 offset:6656
    s_waitcnt lgkmcnt(5)
    v_mfma_f32_32x32x16_bf16 v[64:79], v[48:51], v[232:235], v[64:79]
    s_cmp_eq_u32 s48, 6
    s_cbranch_scc1 xr_63_s
xr_63:
    s_waitcnt lgkmcnt(0)
    s_barrier
    ds_read_b128 v[240:243], v16 offset:24576
    ds_read_b64_tr_b16 v[40:41], v20 offset:24576
    ds_read_b64_tr_b16 v[42:43], v20 offset:25088
    v_mfma_f32_32x32x16_bf16 v[80:95], v[52:55], v[232:235], v[80:95]
    ds_read_b64_tr_b16 v[44:45], v21 offset:24576
    ds_read_b64_tr_b16 v[46:47], v21 offset:25088
    v_mfma_f32_32x32x16_bf16 v[64:79], v[32:35], v[236:239], v[64:79]
    ds_read_b128 v[244:247], v17 offset:24576
    ds_read_b64_tr_b16 v[48:49], v20 offset:26624
    ds_read_b64_tr_b16 v[50:51], v20 offset:27136
    v_mfma_f32_32x32x16_bf16 v[80:95], v[36:39], v[236:239], v[80:95]
    ds_read_b64_tr_b16 v[52:53], v21 offset:26624
    ds_read_b64_tr_b16 v[54:55], v21 offset:27136
    s_waitcnt lgkmcnt(5)
    v_mfma_f32_32x32x16_bf16 v[64:79], v[40:43], v[240:243], v[64:79]
    ds_read_b128 v[248:251], v18 offset:24576
    ds_read_b64_tr_b16 v[32:33], v20 offset:28672
    ds_read_b64_tr_b16 v[34:35], v20 offset:29184
    v_mfma_f32_32x32x16_bf16 v[80:95], v[44:47], v[240:243], v[80:95]
    ds_read_b64_tr_b16 v[36:37], v21 offset:28672
    ds_read_b64_tr_b16 v[38:39], v21 offset:29184
    s_mov_b64 s[32:33], s[16:17]
    s_mov_b32 s34, 1409024
    s_mov_b32 s35, 0x20000
    s_lshl_b32 s52, s50, 5
    s_add_u32 s52, s52, s51
    s_lshl_b32 s52, s52, 2
    s_add_u32 s52, s52, s44
    s_mul_i32 s52, s52, 1408
    v_min_u32 v5, 10, v1
    v_lshlrev_b32 v5, 7, v5
    buffer_load_dword v23, v5, s[32:35], s52 offen
    s_waitcnt lgkmcnt(5)
    v_mfma_f32_32x32x16_bf16 v[64:79], v[48:51], v[244:247], v[64:79]
    ds_read_b128 v[252:255], v19 offset:24576
    ds_read_b64_tr_b16 v[40:41], v20 offset:30720
    ds_read_b64_tr_b16 v[42:43], v20 offset:31232
    v_mfma_f32_32x32x16_bf16 v[80:95], v[52:55], v[244:247], v[80:95]
    ds_read_b64_tr_b16 v[44:45], v21 offset:30720
    ds_read_b64_tr_b16 v[46:47], v21 offset:31232
    s_waitcnt vmcnt(1)
    v_cmp_ne_u32 vcc, s76, v22
    v_mov_b32 v10, 159876
    s_cmp_eq_u64 vcc, 0
    s_cselect_b32 s2, 1, 0
    v_mov_b32 v11, s2
    s_mov_b64 exec, 1
    ds_max_u32 v10, v11
    s_mov_b64 exec, -1
    s_add_u32 s52, s73, 1
    s_and_b32 s52, s52, 6
    s_cselect_b32 s77, s2, 0
    s_cmp_ge_u32 s96, 8
    s_cselect_b32 s77, 0, s77
    s_waitcnt lgkmcnt(6)
    v_mfma_f32_32x32x16_bf16 v[64:79], v[32:35], v[248:251], v[64:79]
    s_cmp_eq_u32 s48, 7
    s_cbranch_scc1 xr_64_s
xr_64:
    v_add_u32 v20, 77824, v20
    v_add_u32 v21, 77824, v21
    s_waitcnt lgkmcnt(0)
    s_barrier
    ds_read_b64_tr_b16 v[48:49], v20 offset:0
    ds_read_b64_tr_b16 v[50:51], v20 offset:512
    ds_read_b64_tr_b16 v[52:53], v21 offset:0
    v_mfma_f32_32x32x16_bf16 v[80:95], v[36:39], v[248:251], v[80:95]
    ds_read_b64_tr_b16 v[54:55], v21 offset:512
    v_mfma_f32_32x32x16_bf16 v[64:79], v[40:43], v[252:255], v[64:79]
    ds_read_b64_tr_b16 v[32:33], v20 offset:2048
    ds_read_b64_tr_b16 v[34:35], v20 offset:2560
    ds_read_b64_tr_b16 v[36:37], v21 offset:2048
    v_mfma_f32_32x32x16_bf16 v[80:95], v[44:47], v[252:255], v[80:95]
    ds_read_b64_tr_b16 v[38:39], v21 offset:2560
    s_cmp_ge_u32 s96, 8
    s_cbranch_scc1 P1KV_65
    s_waitcnt lgkmcnt(4)
    v_mfma_f32_32x32x16_bf16 v[96:111], v[48:51], v[128:131], 0
    ds_read_b64_tr_b16 v[40:41], v20 offset:4096
    ds_read_b64_tr_b16 v[42:43], v20 offset:4608
    v_mfma_f32_32x32x16_bf16 v[112:127], v[52:55], v[128:131], 0
    ds_read_b64_tr_b16 v[44:45], v21 offset:4096
    ds_read_b64_tr_b16 v[46:47], v21 offset:4608
    v_mul_f32 v64, 0x3eb8aa3b, v64
    v_mul_f32 v65, 0x3eb8aa3b, v65
    v_mul_f32 v66, 0x3eb8aa3b, v66
    v_mul_f32 v67, 0x3eb8aa3b, v67
    s_waitcnt lgkmcnt(4)
    v_mfma_f32_32x32x16_bf16 v[96:111], v[32:35], v[132:135], v[96:111]
    ds_read_b64_tr_b16 v[48:49], v20 offset:6144
    ds_read_b64_tr_b16 v[50:51], v20 offset:6656
    v_mul_f32 v68, 0x3eb8aa3b, v68
    v_mul_f32 v69, 0x3eb8aa3b, v69
    v_mul_f32 v70, 0x3eb8aa3b, v70
    v_mul_f32 v71, 0x3eb8aa3b, v71
    v_mfma_f32_32x32x16_bf16 v[112:127], v[36:39], v[132:135], v[112:127]
    ds_read_b64_tr_b16 v[52:53], v21 offset:6144
    ds_read_b64_tr_b16 v[54:55], v21 offset:6656
    v_mul_f32 v72, 0x3eb8aa3b, v72
    v_mul_f32 v73, 0x3eb8aa3b, v73
    v_mul_f32 v74, 0x3eb8aa3b, v74
    v_mul_f32 v75, 0x3eb8aa3b, v75
    s_waitcnt lgkmcnt(4)
    v_mfma_f32_32x32x16_bf16 v[96:111], v[40:43], v[136:139], v[96:111]
    ds_read_b64_tr_b16 v[32:33], v20 offset:8192
    ds_read_b64_tr_b16 v[34:35], v20 offset:8704
    v_mul_f32 v76, 0x3eb8aa3b, v76
    v_mul_f32 v77, 0x3eb8aa3b, v77
    v_mul_f32 v78, 0x3eb8aa3b, v78
    v_mul_f32 v79, 0x3eb8aa3b, v79
    v_mfma_f32_32x32x16_bf16 v[112:127], v[44:47], v[136:139], v[112:127]
    ds_read_b64_tr_b16 v[36:37], v21 offset:8192
    ds_read_b64_tr_b16 v[38:39], v21 offset:8704
    v_cvt_pk_bf16_f32 v64, v64, v65
    v_cvt_pk_bf16_f32 v65, v66, v67
    v_cvt_pk_bf16_f32 v66, v68, v69
    v_cvt_pk_bf16_f32 v67, v70, v71
    s_waitcnt lgkmcnt(4)
    v_mfma_f32_32x32x16_bf16 v[96:111], v[48:51], v[140:143], v[96:111]
    ds_read_b64_tr_b16 v[40:41], v20 offset:10240
    ds_read_b64_tr_b16 v[42:43], v20 offset:10752
    v_cvt_pk_bf16_f32 v68, v72, v73
    v_cvt_pk_bf16_f32 v69, v74, v75
    v_cvt_pk_bf16_f32 v70, v76, v77
    v_cvt_pk_bf16_f32 v71, v78, v79
    v_mfma_f32_32x32x16_bf16 v[112:127], v[52:55], v[140:143], v[112:127]
    ds_read_b64_tr_b16 v[44:45], v21 offset:10240
    ds_read_b64_tr_b16 v[46:47], v21 offset:10752
    buffer_store_dwordx4 v[64:67], v2, s[28:31], s68 offen sc1
    buffer_store_dwordx4 v[68:71], v9, s[28:31], s68 offen sc1
    v_mul_f32 v80, 0x3eb8aa3b, v80
    v_mul_f32 v81, 0x3eb8aa3b, v81
    s_waitcnt lgkmcnt(4)
    v_mfma_f32_32x32x16_bf16 v[96:111], v[32:35], v[144:147], v[96:111]
    ds_read_b64_tr_b16 v[48:49], v20 offset:12288
    ds_read_b64_tr_b16 v[50:51], v20 offset:12800
    v_mul_f32 v82, 0x3eb8aa3b, v82
    v_mul_f32 v83, 0x3eb8aa3b, v83
    v_mul_f32 v84, 0x3eb8aa3b, v84
    v_mul_f32 v85, 0x3eb8aa3b, v85
    v_mfma_f32_32x32x16_bf16 v[112:127], v[36:39], v[144:147], v[112:127]
    ds_read_b64_tr_b16 v[52:53], v21 offset:12288
    ds_read_b64_tr_b16 v[54:55], v21 offset:12800
    v_mul_f32 v86, 0x3eb8aa3b, v86
    v_mul_f32 v87, 0x3eb8aa3b, v87
    v_mul_f32 v88, 0x3eb8aa3b, v88
    v_mul_f32 v89, 0x3eb8aa3b, v89
    s_waitcnt lgkmcnt(4)
    v_mfma_f32_32x32x16_bf16 v[96:111], v[40:43], v[148:151], v[96:111]
    ds_read_b64_tr_b16 v[32:33], v20 offset:14336
    ds_read_b64_tr_b16 v[34:35], v20 offset:14848
    v_mul_f32 v90, 0x3eb8aa3b, v90
    v_mul_f32 v91, 0x3eb8aa3b, v91
    v_mul_f32 v92, 0x3eb8aa3b, v92
    v_mul_f32 v93, 0x3eb8aa3b, v93
    v_mfma_f32_32x32x16_bf16 v[112:127], v[44:47], v[148:151], v[112:127]
    ds_read_b64_tr_b16 v[36:37], v21 offset:14336
    ds_read_b64_tr_b16 v[38:39], v21 offset:14848
    v_mul_f32 v94, 0x3eb8aa3b, v94
    v_mul_f32 v95, 0x3eb8aa3b, v95
    v_cvt_pk_bf16_f32 v80, v80, v81
    v_cvt_pk_bf16_f32 v81, v82, v83
    s_waitcnt lgkmcnt(4)
    v_mfma_f32_32x32x16_bf16 v[96:111], v[48:51], v[152:155], v[96:111]
    ds_read_b64_tr_b16 v[40:41], v20 offset:16384
    ds_read_b64_tr_b16 v[42:43], v20 offset:16896
    v_cvt_pk_bf16_f32 v82, v84, v85
    v_cvt_pk_bf16_f32 v83, v86, v87
    v_cvt_pk_bf16_f32 v84, v88, v89
    v_cvt_pk_bf16_f32 v85, v90, v91
    v_mfma_f32_32x32x16_bf16 v[112:127], v[52:55], v[152:155], v[112:127]
    ds_read_b64_tr_b16 v[44:45], v21 offset:16384
    ds_read_b64_tr_b16 v[46:47], v21 offset:16896
    v_cvt_pk_bf16_f32 v86, v92, v93
    v_cvt_pk_bf16_f32 v87, v94, v95
    buffer_store_dwordx4 v[80:83], v2, s[28:31], s69 offen sc1
    buffer_store_dwordx4 v[84:87], v9, s[28:31], s69 offen sc1
    s_waitcnt lgkmcnt(4)
    v_mfma_f32_32x32x16_bf16 v[96:111], v[32:35], v[156:159], v[96:111]
    ds_read_b64_tr_b16 v[48:49], v20 offset:18432
    ds_read_b64_tr_b16 v[50:51], v20 offset:18944
    v_mfma_f32_32x32x16_bf16 v[112:127], v[36:39], v[156:159], v[112:127]
    ds_read_b64_tr_b16 v[52:53], v21 offset:18432
    ds_read_b64_tr_b16 v[54:55], v21 offset:18944
    s_waitcnt lgkmcnt(4)
    v_mfma_f32_32x32x16_bf16 v[96:111], v[40:43], v[160:163], v[96:111]
    ds_read_b64_tr_b16 v[32:33], v20 offset:20480
    ds_read_b64_tr_b16 v[34:35], v20 offset:20992
    v_mfma_f32_32x32x16_bf16 v[112:127], v[44:47], v[160:163], v[112:127]
    ds_read_b64_tr_b16 v[36:37], v21 offset:20480
    ds_read_b64_tr_b16 v[38:39], v21 offset:20992
    s_waitcnt lgkmcnt(4)
    v_mfma_f32_32x32x16_bf16 v[96:111], v[48:51], v[164:167], v[96:111]
    ds_read_b64_tr_b16 v[40:41], v20 offset:22528
    ds_read_b64_tr_b16 v[42:43], v20 offset:23040
    v_mfma_f32_32x32x16_bf16 v[112:127], v[52:55], v[164:167], v[112:127]
    ds_read_b64_tr_b16 v[44:45], v21 offset:22528
    ds_read_b64_tr_b16 v[46:47], v21 offset:23040
    s_waitcnt lgkmcnt(4)
    v_mfma_f32_32x32x16_bf16 v[96:111], v[32:35], v[168:171], v[96:111]
    ds_read_b64_tr_b16 v[48:49], v20 offset:24576
    ds_read_b64_tr_b16 v[50:51], v20 offset:25088
    v_mfma_f32_32x32x16_bf16 v[112:127], v[36:39], v[168:171], v[112:127]
    ds_read_b64_tr_b16 v[52:53], v21 offset:24576
    ds_read_b64_tr_b16 v[54:55], v21 offset:25088
    s_waitcnt lgkmcnt(4)
    v_mfma_f32_32x32x16_bf16 v[96:111], v[40:43], v[172:175], v[96:111]
    ds_read_b64_tr_b16 v[32:33], v20 offset:26624
    ds_read_b64_tr_b16 v[34:35], v20 offset:27136
    v_mfma_f32_32x32x16_bf16 v[112:127], v[44:47], v[172:175], v[112:127]
    ds_read_b64_tr_b16 v[36:37], v21 offset:26624
    ds_read_b64_tr_b16 v[38:39], v21 offset:27136
    s_waitcnt lgkmcnt(4)
    v_mfma_f32_32x32x16_bf16 v[96:111], v[48:51], v[176:179], v[96:111]
    ds_read_b64_tr_b16 v[40:41], v20 offset:28672
    ds_read_b64_tr_b16 v[42:43], v20 offset:29184
    v_mfma_f32_32x32x16_bf16 v[112:127], v[52:55], v[176:179], v[112:127]
    ds_read_b64_tr_b16 v[44:45], v21 offset:28672
    ds_read_b64_tr_b16 v[46:47], v21 offset:29184
    s_waitcnt lgkmcnt(4)
    v_mfma_f32_32x32x16_bf16 v[96:111], v[32:35], v[180:183], v[96:111]
    ds_read_b64_tr_b16 v[48:49], v20 offset:30720
    ds_read_b64_tr_b16 v[50:51], v20 offset:31232
    v_mfma_f32_32x32x16_bf16 v[112:127], v[36:39], v[180:183], v[112:127]
    ds_read_b64_tr_b16 v[52:53], v21 offset:30720
    ds_read_b64_tr_b16 v[54:55], v21 offset:31232
    s_waitcnt lgkmcnt(4)
    v_mfma_f32_32x32x16_bf16 v[96:111], v[40:43], v[184:187], v[96:111]
    ds_read_b64_tr_b16 v[32:33], v20 offset:32768
    ds_read_b64_tr_b16 v[34:35], v20 offset:33280
    v_mfma_f32_32x32x16_bf16 v[112:127], v[44:47], v[184:187], v[112:127]
    ds_read_b64_tr_b16 v[36:37], v21 offset:32768
    ds_read_b64_tr_b16 v[38:39], v21 offset:33280
    s_waitcnt lgkmcnt(4)
    v_mfma_f32_32x32x16_bf16 v[96:111], v[48:51], v[188:191], v[96:111]
    ds_read_b64_tr_b16 v[40:41], v20 offset:34816
    ds_read_b64_tr_b16 v[42:43], v20 offset:35328
    v_mfma_f32_32x32x16_bf16 v[112:127], v[52:55], v[188:191], v[112:127]
    ds_read_b64_tr_b16 v[44:45], v21 offset:34816
    ds_read_b64_tr_b16 v[46:47], v21 offset:35328
    s_waitcnt lgkmcnt(4)
    v_mfma_f32_32x32x16_bf16 v[96:111], v[32:35], v[192:195], v[96:111]
    ds_read_b64_tr_b16 v[48:49], v20 offset:36864
    ds_read_b64_tr_b16 v[50:51], v20 offset:37376
    v_mfma_f32_32x32x16_bf16 v[112:127], v[36:39], v[192:195], v[112:127]
    ds_read_b64_tr_b16 v[52:53], v21 offset:36864
    ds_read_b64_tr_b16 v[54:55], v21 offset:37376
    s_waitcnt lgkmcnt(4)
    v_mfma_f32_32x32x16_bf16 v[96:111], v[40:43], v[196:199], v[96:111]
    ds_read_b64_tr_b16 v[32:33], v20 offset:38912
    ds_read_b64_tr_b16 v[34:35], v20 offset:39424
    v_mfma_f32_32x32x16_bf16 v[112:127], v[44:47], v[196:199], v[112:127]
    ds_read_b64_tr_b16 v[36:37], v21 offset:38912
    ds_read_b64_tr_b16 v[38:39], v21 offset:39424
    s_waitcnt lgkmcnt(4)
    v_mfma_f32_32x32x16_bf16 v[96:111], v[48:51], v[200:203], v[96:111]
    ds_read_b64_tr_b16 v[40:41], v20 offset:40960
    ds_read_b64_tr_b16 v[42:43], v20 offset:41472
    s_waitcnt vmcnt(0)
    v_mov_b32 v10, s3
    s_add_u32 s10, s72, 65536
    s_mov_b64 exec, 1
    buffer_store_dword v10, off, s[28:31], s10
    s_cmp_lg_u32 s2, 0
    s_cbranch_scc1 gf_67
    buffer_store_dword v10, off, s[28:31], s74 sc1
gf_67:
    s_mov_b64 exec, -1
    v_cmp_ne_u32 vcc, s3, v31
    s_nop 0
    s_cbranch_vccz rs_ok_68
    v_lshlrev_b32 v5, 4, v3
    s_lshl_b32 s54, s73, 9
    s_add_u32 s54, s54, 20578304
    s_mov_b32 s10, 0x20000
rs_69:
    buffer_load_dwordx4 v[28:31], v5, s[28:31], s54 offen offset:0 sc1
    s_waitcnt vmcnt(0)
    v_cmp_ne_u32 vcc, s3, v31
    s_nop 0
    s_cbranch_vccz rs_done_70
    s_sub_u32 s10, s10, 1
    s_cbranch_scc0 rs_69
rs_done_70:
rs_ok_68:
    v_sub_f32 v28, 0, v28
    v_cvt_pk_bf16_f32 v16, v28, v28
    v_and_b32 v30, 0xffff0000, v16
    v_sub_f32 v30, v28, v30
    v_cvt_pk_bf16_f32 v17, v30, 0
    v_mov_b32 v18, 0
    v_mov_b32 v19, 0
    v_mov_b32 v28, v29
    v_mov_b32 v72, 0xc0135761
    v_mov_b32 v73, 0xc0135761
    v_mov_b32 v74, 0xbdd2d3e8
    v_mov_b32 v75, 0xbdd2d3e8
    v_mov_b32 v76, 1.0
    v_mov_b32 v77, 1.0
    v_mfma_f32_32x32x16_bf16 v[112:127], v[52:55], v[200:203], v[112:127]
    ds_read_b64_tr_b16 v[44:45], v21 offset:40960
    ds_read_b64_tr_b16 v[46:47], v21 offset:41472
    s_waitcnt lgkmcnt(4)
    v_mfma_f32_32x32x16_bf16 v[96:111], v[32:35], v[204:207], v[96:111]
    ds_read_b64_tr_b16 v[48:49], v20 offset:43008
    ds_read_b64_tr_b16 v[50:51], v20 offset:43520
    v_mfma_f32_32x32x16_bf16 v[112:127], v[36:39], v[204:207], v[112:127]
    ds_read_b64_tr_b16 v[52:53], v21 offset:43008
    ds_read_b64_tr_b16 v[54:55], v21 offset:43520
    s_waitcnt lgkmcnt(4)
    v_mfma_f32_32x32x16_bf16 v[96:111], v[40:43], v[208:211], v[96:111]
    ds_read_b64_tr_b16 v[32:33], v20 offset:45056
    ds_read_b64_tr_b16 v[34:35], v20 offset:45568
    v_mfma_f32_32x32x16_bf16 v[112:127], v[44:47], v[208:211], v[112:127]
    ds_read_b64_tr_b16 v[36:37], v21 offset:45056
    ds_read_b64_tr_b16 v[38:39], v21 offset:45568
    s_waitcnt lgkmcnt(4)
    v_mfma_f32_32x32x16_bf16 v[96:111], v[48:51], v[212:215], v[96:111]
    ds_read_b64_tr_b16 v[40:41], v20 offset:47104
    ds_read_b64_tr_b16 v[42:43], v20 offset:47616
    v_mfma_f32_32x32x16_bf16 v[112:127], v[52:55], v[212:215], v[112:127]
    ds_read_b64_tr_b16 v[44:45], v21 offset:47104
    ds_read_b64_tr_b16 v[46:47], v21 offset:47616
    s_waitcnt lgkmcnt(4)
    v_mfma_f32_32x32x16_bf16 v[96:111], v[32:35], v[216:219], v[96:111]
    ds_read_b64_tr_b16 v[48:49], v20 offset:49152
    ds_read_b64_tr_b16 v[50:51], v20 offset:49664
    v_mfma_f32_32x32x16_bf16 v[112:127], v[36:39], v[216:219], v[112:127]
    ds_read_b64_tr_b16 v[52:53], v21 offset:49152
    ds_read_b64_tr_b16 v[54:55], v21 offset:49664
    s_waitcnt lgkmcnt(4)
    v_mfma_f32_32x32x16_bf16 v[96:111], v[40:43], v[220:223], v[96:111]
    ds_read_b64_tr_b16 v[32:33], v20 offset:51200
    ds_read_b64_tr_b16 v[34:35], v20 offset:51712
    v_mfma_f32_32x32x16_bf16 v[112:127], v[44:47], v[220:223], v[112:127]
    ds_read_b64_tr_b16 v[36:37], v21 offset:51200
    ds_read_b64_tr_b16 v[38:39], v21 offset:51712
    s_waitcnt lgkmcnt(4)
    v_mfma_f32_32x32x16_bf16 v[96:111], v[48:51], v[224:227], v[96:111]
    ds_read_b64_tr_b16 v[40:41], v20 offset:53248
    ds_read_b64_tr_b16 v[42:43], v20 offset:53760
    v_mfma_f32_32x32x16_bf16 v[112:127], v[52:55], v[224:227], v[112:127]
    ds_read_b64_tr_b16 v[44:45], v21 offset:53248
    ds_read_b64_tr_b16 v[46:47], v21 offset:53760
    s_waitcnt lgkmcnt(4)
    v_mfma_f32_32x32x16_bf16 v[96:111], v[32:35], v[228:231], v[96:111]
    ds_read_b64_tr_b16 v[48:49], v20 offset:55296
    ds_read_b64_tr_b16 v[50:51], v20 offset:55808
    v_mfma_f32_32x32x16_bf16 v[112:127], v[36:39], v[228:231], v[112:127]
    ds_read_b64_tr_b16 v[52:53], v21 offset:55296
    ds_read_b64_tr_b16 v[54:55], v21 offset:55808
    s_waitcnt lgkmcnt(4)
    v_mfma_f32_32x32x16_bf16 v[96:111], v[40:43], v[232:235], v[96:111]
    ds_read_b64_tr_b16 v[32:33], v20 offset:57344
    ds_read_b64_tr_b16 v[34:35], v20 offset:57856
    v_mfma_f32_32x32x16_bf16 v[112:127], v[44:47], v[232:235], v[112:127]
    ds_read_b64_tr_b16 v[36:37], v21 offset:57344
    ds_read_b64_tr_b16 v[38:39], v21 offset:57856
    s_waitcnt lgkmcnt(4)
    v_mfma_f32_32x32x16_bf16 v[96:111], v[48:51], v[236:239], v[96:111]
    ds_read_b64_tr_b16 v[40:41], v20 offset:59392
    ds_read_b64_tr_b16 v[42:43], v20 offset:59904
    v_mfma_f32_32x32x16_bf16 v[112:127], v[52:55], v[236:239], v[112:127]
    ds_read_b64_tr_b16 v[44:45], v21 offset:59392
    ds_read_b64_tr_b16 v[46:47], v21 offset:59904
    s_waitcnt lgkmcnt(4)
    v_mfma_f32_32x32x16_bf16 v[96:111], v[32:35], v[240:243], v[96:111]
    ds_read_b64_tr_b16 v[48:49], v20 offset:61440
    ds_read_b64_tr_b16 v[50:51], v20 offset:61952
    v_mfma_f32_32x32x16_bf16 v[112:127], v[36:39], v[240:243], v[112:127]
    ds_read_b64_tr_b16 v[52:53], v21 offset:61440
    ds_read_b64_tr_b16 v[54:55], v21 offset:61952
    s_waitcnt lgkmcnt(4)
    v_mfma_f32_32x32x16_bf16 v[96:111], v[40:43], v[244:247], v[96:111]
    ds_read_b64_tr_b16 v[32:33], v20 offset:63488
    ds_read_b64_tr_b16 v[34:35], v20 offset:64000
    v_mov_b32 v10, 159756
    s_mov_b32 s10, 0x200000
aw_71:
    ds_read_b32 v11, v10
    s_waitcnt lgkmcnt(0)
    v_cmp_gt_u32 vcc, 4, v11
    s_nop 0
    s_cbranch_vccz aw_done_72
    s_sleep 1
    s_sub_u32 s10, s10, 1
    s_cbranch_scc0 aw_71
aw_done_72:
    v_lshlrev_b32 v5, 2, v3
    v_add_u32 v5, 161792, v5
    ds_read2_b32 v[88:89], v5 offset0:0 offset1:32
    ds_read2_b32 v[90:91], v5 offset0:64 offset1:96
    ds_read2_b32 v[92:93], v5 offset0:128 offset1:160
    ds_read2_b32 v[94:95], v5 offset0:192 offset1:224
    v_mfma_f32_32x32x16_bf16 v[112:127], v[44:47], v[244:247], v[112:127]
    ds_read_b64_tr_b16 v[36:37], v21 offset:63488
    ds_read_b64_tr_b16 v[38:39], v21 offset:64000
    v_mfma_f32_32x32x16_bf16 v[96:111], v[48:51], v[248:251], v[96:111]
    v_mfma_f32_32x32x16_bf16 v[112:127], v[52:55], v[248:251], v[112:127]
    s_waitcnt lgkmcnt(2)
    v_cmp_eq_u32 vcc, 0, v4
    v_add_f32 v88, v88, v90
    v_add_f32 v92, v92, v94
    v_add_f32 v88, v88, v92
    v_cndmask_b32 v88, 0, v88, vcc
    v_add_f32 v89, v89, v91
    v_add_f32 v93, v93, v95
    v_add_f32 v89, v89, v93
    v_cndmask_b32 v89, 0, v89, vcc
    v_cvt_pk_bf16_f32 v129, v88, 0
    v_lshlrev_b32 v90, 16, v129
    v_sub_f32 v90, v88, v90
    v_cvt_pk_bf16_f32 v128, v88, v90
    v_mov_b32 v130, 0
    v_mov_b32 v131, 0
    v_cvt_pk_bf16_f32 v133, v89, 0
    v_lshlrev_b32 v90, 16, v133
    v_sub_f32 v90, v89, v90
    v_cvt_pk_bf16_f32 v132, v89, v90
    v_mov_b32 v134, 0
    v_mov_b32 v135, 0
    s_waitcnt lgkmcnt(0)
    v_mfma_f32_32x32x16_bf16 v[96:111], v[32:35], v[252:255], v[96:111]
    v_mfma_f32_32x32x16_bf16 v[112:127], v[36:39], v[252:255], v[112:127]
    v_mfma_f32_32x32x16_bf16 v[96:111], v[128:131], v[16:19], v[96:111]
    v_mfma_f32_32x32x16_bf16 v[112:127], v[132:135], v[16:19], v[112:127]
    s_setprio 2
    s_nop 9
    v_pk_mul_f32 v[96:97], v[96:97], v[28:29]
    v_pk_mul_f32 v[98:99], v[98:99], v[28:29]
    v_pk_mul_f32 v[100:101], v[100:101], v[28:29]
    v_pk_mul_f32 v[102:103], v[102:103], v[28:29]
    v_pk_mul_f32 v[104:105], v[104:105], v[28:29]
    v_pk_mul_f32 v[106:107], v[106:107], v[28:29]
    v_pk_mul_f32 v[108:109], v[108:109], v[28:29]
    v_pk_mul_f32 v[110:111], v[110:111], v[28:29]
    v_pk_mul_f32 v[144:145], v[96:97], v[96:97]
    v_pk_mul_f32 v[146:147], v[98:99], v[98:99]
    v_pk_mul_f32 v[148:149], v[100:101], v[100:101]
    v_pk_mul_f32 v[150:151], v[102:103], v[102:103]
    v_pk_mul_f32 v[152:153], v[104:105], v[104:105]
    v_pk_mul_f32 v[154:155], v[106:107], v[106:107]
    v_pk_mul_f32 v[156:157], v[108:109], v[108:109]
    v_pk_mul_f32 v[158:159], v[110:111], v[110:111]
    v_pk_fma_f32 v[144:145], v[144:145], v[74:75], v[72:73]
    v_pk_fma_f32 v[146:147], v[146:147], v[74:75], v[72:73]
    v_pk_fma_f32 v[148:149], v[148:149], v[74:75], v[72:73]
    v_pk_fma_f32 v[150:151], v[150:151], v[74:75], v[72:73]
    v_pk_fma_f32 v[152:153], v[152:153], v[74:75], v[72:73]
    v_pk_fma_f32 v[154:155], v[154:155], v[74:75], v[72:73]
    v_pk_fma_f32 v[156:157], v[156:157], v[74:75], v[72:73]
    v_pk_fma_f32 v[158:159], v[158:159], v[74:75], v[72:73]
    v_pk_mul_f32 v[144:145], v[144:145], v[96:97]
    v_pk_mul_f32 v[146:147], v[146:147], v[98:99]
    v_pk_mul_f32 v[148:149], v[148:149], v[100:101]
    v_pk_mul_f32 v[150:151], v[150:151], v[102:103]
    v_pk_mul_f32 v[152:153], v[152:153], v[104:105]
    v_pk_mul_f32 v[154:155], v[154:155], v[106:107]
    v_pk_mul_f32 v[156:157], v[156:157], v[108:109]
    v_pk_mul_f32 v[158:159], v[158:159], v[110:111]
    v_exp_f32 v144, v144
    v_exp_f32 v145, v145
    v_exp_f32 v146, v146
    v_exp_f32 v147, v147
    v_exp_f32 v148, v148
    v_exp_f32 v149, v149
    v_exp_f32 v150, v150
    v_exp_f32 v151, v151
    v_exp_f32 v152, v152
    v_exp_f32 v153, v153
    v_exp_f32 v154, v154
    v_exp_f32 v155, v155
    v_exp_f32 v156, v156
    v_exp_f32 v157, v157
    v_exp_f32 v158, v158
    v_exp_f32 v159, v159
    v_pk_add_f32 v[144:145], v[144:145], v[76:77]
    v_pk_add_f32 v[146:147], v[146:147], v[76:77]
    v_pk_add_f32 v[148:149], v[148:149], v[76:77]
    v_pk_add_f32 v[150:151], v[150:151], v[76:77]
    v_pk_add_f32 v[152:153], v[152:153], v[76:77]
    v_pk_add_f32 v[154:155], v[154:155], v[76:77]
    v_pk_add_f32 v[156:157], v[156:157], v[76:77]
    v_pk_add_f32 v[158:159], v[158:159], v[76:77]
    v_rcp_f32 v144, v144
    v_rcp_f32 v145, v145
    v_rcp_f32 v146, v146
    v_rcp_f32 v147, v147
    v_rcp_f32 v148, v148
    v_rcp_f32 v149, v149
    v_rcp_f32 v150, v150
    v_rcp_f32 v151, v151
    v_rcp_f32 v152, v152
    v_rcp_f32 v153, v153
    v_rcp_f32 v154, v154
    v_rcp_f32 v155, v155
    v_rcp_f32 v156, v156
    v_rcp_f32 v157, v157
    v_rcp_f32 v158, v158
    v_rcp_f32 v159, v159
    v_pk_mul_f32 v[144:145], v[144:145], v[96:97]
    v_pk_mul_f32 v[146:147], v[146:147], v[98:99]
    v_pk_mul_f32 v[148:149], v[148:149], v[100:101]
    v_pk_mul_f32 v[150:151], v[150:151], v[102:103]
    v_pk_mul_f32 v[152:153], v[152:153], v[104:105]
    v_pk_mul_f32 v[154:155], v[154:155], v[106:107]
    v_pk_mul_f32 v[156:157], v[156:157], v[108:109]
    v_pk_mul_f32 v[158:159], v[158:159], v[110:111]
    v_cvt_pk_bf16_f32 v96, v144, v145
    v_cvt_pk_bf16_f32 v97, v146, v147
    v_cvt_pk_bf16_f32 v98, v148, v149
    v_cvt_pk_bf16_f32 v99, v150, v151
    v_cvt_pk_bf16_f32 v100, v152, v153
    v_cvt_pk_bf16_f32 v101, v154, v155
    v_cvt_pk_bf16_f32 v102, v156, v157
    v_cvt_pk_bf16_f32 v103, v158, v159
    buffer_store_dwordx4 v[96:99], v2, s[28:31], s70 offen sc1
    buffer_store_dwordx4 v[100:103], v2, s[28:31], s70 offen offset:1024 sc1
    v_pk_mul_f32 v[112:113], v[112:113], v[28:29]
    v_pk_mul_f32 v[114:115], v[114:115], v[28:29]
    v_pk_mul_f32 v[116:117], v[116:117], v[28:29]
    v_pk_mul_f32 v[118:119], v[118:119], v[28:29]
    v_pk_mul_f32 v[120:121], v[120:121], v[28:29]
    v_pk_mul_f32 v[122:123], v[122:123], v[28:29]
    v_pk_mul_f32 v[124:125], v[124:125], v[28:29]
    v_pk_mul_f32 v[126:127], v[126:127], v[28:29]
    v_pk_mul_f32 v[144:145], v[112:113], v[112:113]
    v_pk_mul_f32 v[146:147], v[114:115], v[114:115]
    v_pk_mul_f32 v[148:149], v[116:117], v[116:117]
    v_pk_mul_f32 v[150:151], v[118:119], v[118:119]
    v_pk_mul_f32 v[152:153], v[120:121], v[120:121]
    v_pk_mul_f32 v[154:155], v[122:123], v[122:123]
    v_pk_mul_f32 v[156:157], v[124:125], v[124:125]
    v_pk_mul_f32 v[158:159], v[126:127], v[126:127]
    v_pk_fma_f32 v[144:145], v[144:145], v[74:75], v[72:73]
    v_pk_fma_f32 v[146:147], v[146:147], v[74:75], v[72:73]
    v_pk_fma_f32 v[148:149], v[148:149], v[74:75], v[72:73]
    v_pk_fma_f32 v[150:151], v[150:151], v[74:75], v[72:73]
    v_pk_fma_f32 v[152:153], v[152:153], v[74:75], v[72:73]
    v_pk_fma_f32 v[154:155], v[154:155], v[74:75], v[72:73]
    v_pk_fma_f32 v[156:157], v[156:157], v[74:75], v[72:73]
    v_pk_fma_f32 v[158:159], v[158:159], v[74:75], v[72:73]
    v_pk_mul_f32 v[144:145], v[144:145], v[112:113]
    v_pk_mul_f32 v[146:147], v[146:147], v[114:115]
    v_pk_mul_f32 v[148:149], v[148:149], v[116:117]
    v_pk_mul_f32 v[150:151], v[150:151], v[118:119]
    v_pk_mul_f32 v[152:153], v[152:153], v[120:121]
    v_pk_mul_f32 v[154:155], v[154:155], v[122:123]
    v_pk_mul_f32 v[156:157], v[156:157], v[124:125]
    v_pk_mul_f32 v[158:159], v[158:159], v[126:127]
    v_exp_f32 v144, v144
    v_exp_f32 v145, v145
    v_exp_f32 v146, v146
    v_exp_f32 v147, v147
    v_exp_f32 v148, v148
    v_exp_f32 v149, v149
    v_exp_f32 v150, v150
    v_exp_f32 v151, v151
    v_exp_f32 v152, v152
    v_exp_f32 v153, v153
    v_exp_f32 v154, v154
    v_exp_f32 v155, v155
    v_exp_f32 v156, v156
    v_exp_f32 v157, v157
    v_exp_f32 v158, v158
    v_exp_f32 v159, v159
    v_pk_add_f32 v[144:145], v[144:145], v[76:77]
    v_pk_add_f32 v[146:147], v[146:147], v[76:77]
    v_pk_add_f32 v[148:149], v[148:149], v[76:77]
    v_pk_add_f32 v[150:151], v[150:151], v[76:77]
    v_pk_add_f32 v[152:153], v[152:153], v[76:77]
    v_pk_add_f32 v[154:155], v[154:155], v[76:77]
    v_pk_add_f32 v[156:157], v[156:157], v[76:77]
    v_pk_add_f32 v[158:159], v[158:159], v[76:77]
    v_rcp_f32 v144, v144
    v_rcp_f32 v145, v145
    v_rcp_f32 v146, v146
    v_rcp_f32 v147, v147
    v_rcp_f32 v148, v148
    v_rcp_f32 v149, v149
    v_rcp_f32 v150, v150
    v_rcp_f32 v151, v151
    v_rcp_f32 v152, v152
    v_rcp_f32 v153, v153
    v_rcp_f32 v154, v154
    v_rcp_f32 v155, v155
    v_rcp_f32 v156, v156
    v_rcp_f32 v157, v157
    v_rcp_f32 v158, v158
    v_rcp_f32 v159, v159
    v_pk_mul_f32 v[144:145], v[144:145], v[112:113]
    v_pk_mul_f32 v[146:147], v[146:147], v[114:115]
    v_pk_mul_f32 v[148:149], v[148:149], v[116:117]
    v_pk_mul_f32 v[150:151], v[150:151], v[118:119]
    v_pk_mul_f32 v[152:153], v[152:153], v[120:121]
    v_pk_mul_f32 v[154:155], v[154:155], v[122:123]
    v_pk_mul_f32 v[156:157], v[156:157], v[124:125]
    v_pk_mul_f32 v[158:159], v[158:159], v[126:127]
    v_cvt_pk_bf16_f32 v112, v144, v145
    v_cvt_pk_bf16_f32 v113, v146, v147
    v_cvt_pk_bf16_f32 v114, v148, v149
    v_cvt_pk_bf16_f32 v115, v150, v151
    v_cvt_pk_bf16_f32 v116, v152, v153
    v_cvt_pk_bf16_f32 v117, v154, v155
    v_cvt_pk_bf16_f32 v118, v156, v157
    v_cvt_pk_bf16_f32 v119, v158, v159
    buffer_store_dwordx4 v[112:115], v2, s[28:31], s70 offen offset:2048 sc1
    buffer_store_dwordx4 v[116:119], v2, s[28:31], s70 offen offset:3072 sc1
    s_branch P1P_66
P1KV_65:
    s_waitcnt lgkmcnt(4)
    v_mfma_f32_32x32x16_bf16 v[96:111], v[128:131], v[48:51], 0
    ds_read_b64_tr_b16 v[40:41], v20 offset:4096
    ds_read_b64_tr_b16 v[42:43], v20 offset:4608
    v_mfma_f32_32x32x16_bf16 v[112:127], v[128:131], v[52:55], 0
    ds_read_b64_tr_b16 v[44:45], v21 offset:4096
    ds_read_b64_tr_b16 v[46:47], v21 offset:4608
    v_cvt_pk_bf16_f32 v64, v64, v65
    v_cvt_pk_bf16_f32 v65, v66, v67
    v_cvt_pk_bf16_f32 v66, v68, v69
    v_cvt_pk_bf16_f32 v67, v70, v71
    s_waitcnt lgkmcnt(4)
    v_mfma_f32_32x32x16_bf16 v[96:111], v[132:135], v[32:35], v[96:111]
    ds_read_b64_tr_b16 v[48:49], v20 offset:6144
    ds_read_b64_tr_b16 v[50:51], v20 offset:6656
    v_cvt_pk_bf16_f32 v68, v72, v73
    v_cvt_pk_bf16_f32 v69, v74, v75
    v_cvt_pk_bf16_f32 v70, v76, v77
    v_cvt_pk_bf16_f32 v71, v78, v79
    v_mfma_f32_32x32x16_bf16 v[112:127], v[132:135], v[36:39], v[112:127]
    ds_read_b64_tr_b16 v[52:53], v21 offset:6144
    ds_read_b64_tr_b16 v[54:55], v21 offset:6656
    buffer_store_dwordx4 v[64:67], v2, s[28:31], s68 offen sc1
    buffer_store_dwordx4 v[68:71], v9, s[28:31], s68 offen sc1
    v_cvt_pk_bf16_f32 v80, v80, v81
    v_cvt_pk_bf16_f32 v81, v82, v83
    s_waitcnt lgkmcnt(4)
    v_mfma_f32_32x32x16_bf16 v[96:111], v[136:139], v[40:43], v[96:111]
    ds_read_b64_tr_b16 v[32:33], v20 offset:8192
    ds_read_b64_tr_b16 v[34:35], v20 offset:8704
    v_cvt_pk_bf16_f32 v82, v84, v85
    v_cvt_pk_bf16_f32 v83, v86, v87
    v_cvt_pk_bf16_f32 v84, v88, v89
    v_cvt_pk_bf16_f32 v85, v90, v91
    v_mfma_f32_32x32x16_bf16 v[112:127], v[136:139], v[44:47], v[112:127]
    ds_read_b64_tr_b16 v[36:37], v21 offset:8192
    ds_read_b64_tr_b16 v[38:39], v21 offset:8704
    v_cvt_pk_bf16_f32 v86, v92, v93
    v_cvt_pk_bf16_f32 v87, v94, v95
    buffer_store_dwordx4 v[80:83], v2, s[28:31], s69 offen sc1
    buffer_store_dwordx4 v[84:87], v9, s[28:31], s69 offen sc1
    s_waitcnt lgkmcnt(4)
    v_mfma_f32_32x32x16_bf16 v[96:111], v[140:143], v[48:51], v[96:111]
    ds_read_b64_tr_b16 v[40:41], v20 offset:10240
    ds_read_b64_tr_b16 v[42:43], v20 offset:10752
    v_mfma_f32_32x32x16_bf16 v[112:127], v[140:143], v[52:55], v[112:127]
    ds_read_b64_tr_b16 v[44:45], v21 offset:10240
    ds_read_b64_tr_b16 v[46:47], v21 offset:10752
    s_waitcnt lgkmcnt(4)
    v_mfma_f32_32x32x16_bf16 v[96:111], v[144:147], v[32:35], v[96:111]
    ds_read_b64_tr_b16 v[48:49], v20 offset:12288
    ds_read_b64_tr_b16 v[50:51], v20 offset:12800
    v_mfma_f32_32x32x16_bf16 v[112:127], v[144:147], v[36:39], v[112:127]
    ds_read_b64_tr_b16 v[52:53], v21 offset:12288
    ds_read_b64_tr_b16 v[54:55], v21 offset:12800
    s_waitcnt lgkmcnt(4)
    v_mfma_f32_32x32x16_bf16 v[96:111], v[148:151], v[40:43], v[96:111]
    ds_read_b64_tr_b16 v[32:33], v20 offset:14336
    ds_read_b64_tr_b16 v[34:35], v20 offset:14848
    v_mfma_f32_32x32x16_bf16 v[112:127], v[148:151], v[44:47], v[112:127]
    ds_read_b64_tr_b16 v[36:37], v21 offset:14336
    ds_read_b64_tr_b16 v[38:39], v21 offset:14848
    s_waitcnt lgkmcnt(4)
    v_mfma_f32_32x32x16_bf16 v[96:111], v[152:155], v[48:51], v[96:111]
    ds_read_b64_tr_b16 v[40:41], v20 offset:16384
    ds_read_b64_tr_b16 v[42:43], v20 offset:16896
    v_mfma_f32_32x32x16_bf16 v[112:127], v[152:155], v[52:55], v[112:127]
    ds_read_b64_tr_b16 v[44:45], v21 offset:16384
    ds_read_b64_tr_b16 v[46:47], v21 offset:16896
    s_waitcnt lgkmcnt(4)
    v_mfma_f32_32x32x16_bf16 v[96:111], v[156:159], v[32:35], v[96:111]
    ds_read_b64_tr_b16 v[48:49], v20 offset:18432
    ds_read_b64_tr_b16 v[50:51], v20 offset:18944
    v_mfma_f32_32x32x16_bf16 v[112:127], v[156:159], v[36:39], v[112:127]
    ds_read_b64_tr_b16 v[52:53], v21 offset:18432
    ds_read_b64_tr_b16 v[54:55], v21 offset:18944
    s_waitcnt lgkmcnt(4)
    v_mfma_f32_32x32x16_bf16 v[96:111], v[160:163], v[40:43], v[96:111]
    ds_read_b64_tr_b16 v[32:33], v20 offset:20480
    ds_read_b64_tr_b16 v[34:35], v20 offset:20992
    v_mfma_f32_32x32x16_bf16 v[112:127], v[160:163], v[44:47], v[112:127]
    ds_read_b64_tr_b16 v[36:37], v21 offset:20480
    ds_read_b64_tr_b16 v[38:39], v21 offset:20992
    s_waitcnt lgkmcnt(4)
    v_mfma_f32_32x32x16_bf16 v[96:111], v[164:167], v[48:51], v[96:111]
    ds_read_b64_tr_b16 v[40:41], v20 offset:22528
    ds_read_b64_tr_b16 v[42:43], v20 offset:23040
    v_mfma_f32_32x32x16_bf16 v[112:127], v[164:167], v[52:55], v[112:127]
    ds_read_b64_tr_b16 v[44:45], v21 offset:22528
    ds_read_b64_tr_b16 v[46:47], v21 offset:23040
    s_waitcnt lgkmcnt(4)
    v_mfma_f32_32x32x16_bf16 v[96:111], v[168:171], v[32:35], v[96:111]
    ds_read_b64_tr_b16 v[48:49], v20 offset:24576
    ds_read_b64_tr_b16 v[50:51], v20 offset:25088
    v_mfma_f32_32x32x16_bf16 v[112:127], v[168:171], v[36:39], v[112:127]
    ds_read_b64_tr_b16 v[52:53], v21 offset:24576
    ds_read_b64_tr_b16 v[54:55], v21 offset:25088
    s_waitcnt lgkmcnt(4)
    v_mfma_f32_32x32x16_bf16 v[96:111], v[172:175], v[40:43], v[96:111]
    ds_read_b64_tr_b16 v[32:33], v20 offset:26624
    ds_read_b64_tr_b16 v[34:35], v20 offset:27136
    v_mfma_f32_32x32x16_bf16 v[112:127], v[172:175], v[44:47], v[112:127]
    ds_read_b64_tr_b16 v[36:37], v21 offset:26624
    ds_read_b64_tr_b16 v[38:39], v21 offset:27136
    s_waitcnt lgkmcnt(4)
    v_mfma_f32_32x32x16_bf16 v[96:111], v[176:179], v[48:51], v[96:111]
    ds_read_b64_tr_b16 v[40:41], v20 offset:28672
    ds_read_b64_tr_b16 v[42:43], v20 offset:29184
    v_mfma_f32_32x32x16_bf16 v[112:127], v[176:179], v[52:55], v[112:127]
    ds_read_b64_tr_b16 v[44:45], v21 offset:28672
    ds_read_b64_tr_b16 v[46:47], v21 offset:29184
    s_waitcnt lgkmcnt(4)
    v_mfma_f32_32x32x16_bf16 v[96:111], v[180:183], v[32:35], v[96:111]
    ds_read_b64_tr_b16 v[48:49], v20 offset:30720
    ds_read_b64_tr_b16 v[50:51], v20 offset:31232
    v_mfma_f32_32x32x16_bf16 v[112:127], v[180:183], v[36:39], v[112:127]
    ds_read_b64_tr_b16 v[52:53], v21 offset:30720
    ds_read_b64_tr_b16 v[54:55], v21 offset:31232
    s_waitcnt lgkmcnt(4)
    v_mfma_f32_32x32x16_bf16 v[96:111], v[184:187], v[40:43], v[96:111]
    ds_read_b64_tr_b16 v[32:33], v20 offset:32768
    ds_read_b64_tr_b16 v[34:35], v20 offset:33280
    v_mfma_f32_32x32x16_bf16 v[112:127], v[184:187], v[44:47], v[112:127]
    ds_read_b64_tr_b16 v[36:37], v21 offset:32768
    ds_read_b64_tr_b16 v[38:39], v21 offset:33280
    s_waitcnt lgkmcnt(4)
    v_mfma_f32_32x32x16_bf16 v[96:111], v[188:191], v[48:51], v[96:111]
    ds_read_b64_tr_b16 v[40:41], v20 offset:34816
    ds_read_b64_tr_b16 v[42:43], v20 offset:35328
    v_mfma_f32_32x32x16_bf16 v[112:127], v[188:191], v[52:55], v[112:127]
    ds_read_b64_tr_b16 v[44:45], v21 offset:34816
    ds_read_b64_tr_b16 v[46:47], v21 offset:35328
    s_waitcnt lgkmcnt(4)
    v_mfma_f32_32x32x16_bf16 v[96:111], v[192:195], v[32:35], v[96:111]
    ds_read_b64_tr_b16 v[48:49], v20 offset:36864
    ds_read_b64_tr_b16 v[50:51], v20 offset:37376
    v_mfma_f32_32x32x16_bf16 v[112:127], v[192:195], v[36:39], v[112:127]
    ds_read_b64_tr_b16 v[52:53], v21 offset:36864
    ds_read_b64_tr_b16 v[54:55], v21 offset:37376
    s_waitcnt lgkmcnt(4)
    v_mfma_f32_32x32x16_bf16 v[96:111], v[196:199], v[40:43], v[96:111]
    ds_read_b64_tr_b16 v[32:33], v20 offset:38912
    ds_read_b64_tr_b16 v[34:35], v20 offset:39424
    v_mfma_f32_32x32x16_bf16 v[112:127], v[196:199], v[44:47], v[112:127]
    ds_read_b64_tr_b16 v[36:37], v21 offset:38912
    ds_read_b64_tr_b16 v[38:39], v21 offset:39424
    s_waitcnt lgkmcnt(4)
    v_mfma_f32_32x32x16_bf16 v[96:111], v[200:203], v[48:51], v[96:111]
    ds_read_b64_tr_b16 v[40:41], v20 offset:40960
    ds_read_b64_tr_b16 v[42:43], v20 offset:41472
    s_waitcnt vmcnt(0)
    v_mov_b32 v10, s3
    s_add_u32 s10, s72, 65536
    s_mov_b64 exec, 1
    buffer_store_dword v10, off, s[28:31], s10
    buffer_store_dword v10, off, s[28:31], s74 sc1
    s_mov_b64 exec, -1
    v_mfma_f32_32x32x16_bf16 v[112:127], v[200:203], v[52:55], v[112:127]
    ds_read_b64_tr_b16 v[44:45], v21 offset:40960
    ds_read_b64_tr_b16 v[46:47], v21 offset:41472
    s_waitcnt lgkmcnt(4)
    v_mfma_f32_32x32x16_bf16 v[96:111], v[204:207], v[32:35], v[96:111]
    ds_read_b64_tr_b16 v[48:49], v20 offset:43008
    ds_read_b64_tr_b16 v[50:51], v20 offset:43520
    v_mfma_f32_32x32x16_bf16 v[112:127], v[204:207], v[36:39], v[112:127]
    ds_read_b64_tr_b16 v[52:53], v21 offset:43008
    ds_read_b64_tr_b16 v[54:55], v21 offset:43520
    s_waitcnt lgkmcnt(4)
    v_mfma_f32_32x32x16_bf16 v[96:111], v[208:211], v[40:43], v[96:111]
    ds_read_b64_tr_b16 v[32:33], v20 offset:45056
    ds_read_b64_tr_b16 v[34:35], v20 offset:45568
    v_mfma_f32_32x32x16_bf16 v[112:127], v[208:211], v[44:47], v[112:127]
    ds_read_b64_tr_b16 v[36:37], v21 offset:45056
    ds_read_b64_tr_b16 v[38:39], v21 offset:45568
    s_waitcnt lgkmcnt(4)
    v_mfma_f32_32x32x16_bf16 v[96:111], v[212:215], v[48:51], v[96:111]
    ds_read_b64_tr_b16 v[40:41], v20 offset:47104
    ds_read_b64_tr_b16 v[42:43], v20 offset:47616
    v_mfma_f32_32x32x16_bf16 v[112:127], v[212:215], v[52:55], v[112:127]
    ds_read_b64_tr_b16 v[44:45], v21 offset:47104
    ds_read_b64_tr_b16 v[46:47], v21 offset:47616
    s_waitcnt lgkmcnt(4)
    v_mfma_f32_32x32x16_bf16 v[96:111], v[216:219], v[32:35], v[96:111]
    ds_read_b64_tr_b16 v[48:49], v20 offset:49152
    ds_read_b64_tr_b16 v[50:51], v20 offset:49664
    v_mfma_f32_32x32x16_bf16 v[112:127], v[216:219], v[36:39], v[112:127]
    ds_read_b64_tr_b16 v[52:53], v21 offset:49152
    ds_read_b64_tr_b16 v[54:55], v21 offset:49664
    s_waitcnt lgkmcnt(4)
    v_mfma_f32_32x32x16_bf16 v[96:111], v[220:223], v[40:43], v[96:111]
    ds_read_b64_tr_b16 v[32:33], v20 offset:51200
    ds_read_b64_tr_b16 v[34:35], v20 offset:51712
    v_mfma_f32_32x32x16_bf16 v[112:127], v[220:223], v[44:47], v[112:127]
    ds_read_b64_tr_b16 v[36:37], v21 offset:51200
    ds_read_b64_tr_b16 v[38:39], v21 offset:51712
    s_waitcnt lgkmcnt(4)
    v_mfma_f32_32x32x16_bf16 v[96:111], v[224:227], v[48:51], v[96:111]
    ds_read_b64_tr_b16 v[40:41], v20 offset:53248
    ds_read_b64_tr_b16 v[42:43], v20 offset:53760
    v_mfma_f32_32x32x16_bf16 v[112:127], v[224:227], v[52:55], v[112:127]
    ds_read_b64_tr_b16 v[44:45], v21 offset:53248
    ds_read_b64_tr_b16 v[46:47], v21 offset:53760
    s_waitcnt lgkmcnt(4)
    v_mfma_f32_32x32x16_bf16 v[96:111], v[228:231], v[32:35], v[96:111]
    ds_read_b64_tr_b16 v[48:49], v20 offset:55296
    ds_read_b64_tr_b16 v[50:51], v20 offset:55808
    v_mfma_f32_32x32x16_bf16 v[112:127], v[228:231], v[36:39], v[112:127]
    ds_read_b64_tr_b16 v[52:53], v21 offset:55296
    ds_read_b64_tr_b16 v[54:55], v21 offset:55808
    s_waitcnt lgkmcnt(4)
    v_mfma_f32_32x32x16_bf16 v[96:111], v[232:235], v[40:43], v[96:111]
    ds_read_b64_tr_b16 v[32:33], v20 offset:57344
    ds_read_b64_tr_b16 v[34:35], v20 offset:57856
    v_mfma_f32_32x32x16_bf16 v[112:127], v[232:235], v[44:47], v[112:127]
    ds_read_b64_tr_b16 v[36:37], v21 offset:57344
    ds_read_b64_tr_b16 v[38:39], v21 offset:57856
    s_waitcnt lgkmcnt(4)
    v_mfma_f32_32x32x16_bf16 v[96:111], v[236:239], v[48:51], v[96:111]
    ds_read_b64_tr_b16 v[40:41], v20 offset:59392
    ds_read_b64_tr_b16 v[42:43], v20 offset:59904
    v_mfma_f32_32x32x16_bf16 v[112:127], v[236:239], v[52:55], v[112:127]
    ds_read_b64_tr_b16 v[44:45], v21 offset:59392
    ds_read_b64_tr_b16 v[46:47], v21 offset:59904
    s_waitcnt lgkmcnt(4)
    v_mfma_f32_32x32x16_bf16 v[96:111], v[240:243], v[32:35], v[96:111]
    ds_read_b64_tr_b16 v[48:49], v20 offset:61440
    ds_read_b64_tr_b16 v[50:51], v20 offset:61952
    v_mfma_f32_32x32x16_bf16 v[112:127], v[240:243], v[36:39], v[112:127]
    ds_read_b64_tr_b16 v[52:53], v21 offset:61440
    ds_read_b64_tr_b16 v[54:55], v21 offset:61952
    s_waitcnt lgkmcnt(4)
    v_mfma_f32_32x32x16_bf16 v[96:111], v[244:247], v[40:43], v[96:111]
    ds_read_b64_tr_b16 v[32:33], v20 offset:63488
    ds_read_b64_tr_b16 v[34:35], v20 offset:64000
    v_mfma_f32_32x32x16_bf16 v[112:127], v[244:247], v[44:47], v[112:127]
    ds_read_b64_tr_b16 v[36:37], v21 offset:63488
    ds_read_b64_tr_b16 v[38:39], v21 offset:64000
    s_waitcnt lgkmcnt(4)
    v_mfma_f32_32x32x16_bf16 v[96:111], v[248:251], v[48:51], v[96:111]
    v_mfma_f32_32x32x16_bf16 v[112:127], v[248:251], v[52:55], v[112:127]
    s_waitcnt lgkmcnt(0)
    v_mfma_f32_32x32x16_bf16 v[96:111], v[252:255], v[32:35], v[96:111]
    v_mfma_f32_32x32x16_bf16 v[112:127], v[252:255], v[36:39], v[112:127]
    s_nop 10
    v_cvt_pk_bf16_f32 v96, v96, v97
    v_cvt_pk_bf16_f32 v97, v98, v99
    v_cvt_pk_bf16_f32 v98, v100, v101
    v_cvt_pk_bf16_f32 v99, v102, v103
    v_cvt_pk_bf16_f32 v100, v104, v105
    v_cvt_pk_bf16_f32 v101, v106, v107
    v_cvt_pk_bf16_f32 v102, v108, v109
    v_cvt_pk_bf16_f32 v103, v110, v111
    buffer_store_dwordx4 v[96:99], v6, s[28:31], s70 offen sc1
    buffer_store_dwordx4 v[100:103], v6, s[28:31], s70 offen offset:512 sc1
    v_cvt_pk_bf16_f32 v112, v112, v113
    v_cvt_pk_bf16_f32 v113, v114, v115
    v_cvt_pk_bf16_f32 v114, v116, v117
    v_cvt_pk_bf16_f32 v115, v118, v119
    v_cvt_pk_bf16_f32 v116, v120, v121
    v_cvt_pk_bf16_f32 v117, v122, v123
    v_cvt_pk_bf16_f32 v118, v124, v125
    v_cvt_pk_bf16_f32 v119, v126, v127
    buffer_store_dwordx4 v[112:115], v6, s[28:31], s71 offen sc1
    buffer_store_dwordx4 v[116:119], v6, s[28:31], s71 offen offset:512 sc1
P1P_66:
    s_nop 1
    s_setprio 2
    v_mov_b32 v10, 159764
    s_mov_b32 s10, 0x200000
aw_74:
    ds_read_b32 v11, v10
    s_waitcnt lgkmcnt(0)
    v_cmp_gt_u32 vcc, 4, v11
    s_nop 0
    s_cbranch_vccz aw_done_75
    s_sleep 1
    s_sub_u32 s10, s10, 1
    s_cbranch_scc0 aw_74
aw_done_75:
    ds_read_b64_tr_b16 v[112:113], v7 offset:0
    ds_read_b64_tr_b16 v[114:115], v7 offset:1024
    ds_read_b64_tr_b16 v[116:117], v8 offset:0
    ds_read_b64_tr_b16 v[118:119], v8 offset:1024
    ds_read_b64_tr_b16 v[120:121], v7 offset:2048
    ds_read_b64_tr_b16 v[122:123], v7 offset:3072
    ds_read_b64_tr_b16 v[124:125], v8 offset:2048
    ds_read_b64_tr_b16 v[126:127], v8 offset:3072
    ds_read_b64_tr_b16 v[128:129], v7 offset:4096
    ds_read_b64_tr_b16 v[130:131], v7 offset:5120
    ds_read_b64_tr_b16 v[132:133], v8 offset:4096
    ds_read_b64_tr_b16 v[134:135], v8 offset:5120
    ds_read_b64_tr_b16 v[136:137], v7 offset:6144
    ds_read_b64_tr_b16 v[138:139], v7 offset:7168
    ds_read_b64_tr_b16 v[140:141], v8 offset:6144
    ds_read_b64_tr_b16 v[142:143], v8 offset:7168
    ds_read_b64_tr_b16 v[144:145], v7 offset:8192
    ds_read_b64_tr_b16 v[146:147], v7 offset:9216
    ds_read_b64_tr_b16 v[148:149], v8 offset:8192
    ds_read_b64_tr_b16 v[150:151], v8 offset:9216
    ds_read_b64_tr_b16 v[152:153], v7 offset:10240
    ds_read_b64_tr_b16 v[154:155], v7 offset:11264
    ds_read_b64_tr_b16 v[156:157], v8 offset:10240
    ds_read_b64_tr_b16 v[158:159], v8 offset:11264
    ds_read_b64_tr_b16 v[160:161], v7 offset:12288
    ds_read_b64_tr_b16 v[162:163], v7 offset:13312
    ds_read_b64_tr_b16 v[164:165], v8 offset:12288
    ds_read_b64_tr_b16 v[166:167], v8 offset:13312
    ds_read_b64_tr_b16 v[168:169], v7 offset:14336
    ds_read_b64_tr_b16 v[170:171], v7 offset:15360
    ds_read_b64_tr_b16 v[172:173], v8 offset:14336
    ds_read_b64_tr_b16 v[174:175], v8 offset:15360
    ds_read_b64_tr_b16 v[176:177], v7 offset:16384
    ds_read_b64_tr_b16 v[178:179], v7 offset:17408
    ds_read_b64_tr_b16 v[180:181], v8 offset:16384
    ds_read_b64_tr_b16 v[182:183], v8 offset:17408
    ds_read_b64_tr_b16 v[184:185], v7 offset:18432
    ds_read_b64_tr_b16 v[186:187], v7 offset:19456
    ds_read_b64_tr_b16 v[188:189], v8 offset:18432
    ds_read_b64_tr_b16 v[190:191], v8 offset:19456
    ds_read_b64_tr_b16 v[192:193], v7 offset:20480
    ds_read_b64_tr_b16 v[194:195], v7 offset:21504
    ds_read_b64_tr_b16 v[196:197], v8 offset:20480
    ds_read_b64_tr_b16 v[198:199], v8 offset:21504
    ds_read_b64_tr_b16 v[200:201], v7 offset:22528
    ds_read_b64_tr_b16 v[202:203], v7 offset:23552
    ds_read_b64_tr_b16 v[204:205], v8 offset:22528
    ds_read_b64_tr_b16 v[206:207], v8 offset:23552
    ds_read_b64_tr_b16 v[208:209], v7 offset:24576
    ds_read_b64_tr_b16 v[210:211], v7 offset:25600
    ds_read_b64_tr_b16 v[212:213], v8 offset:24576
    ds_read_b64_tr_b16 v[214:215], v8 offset:25600
    ds_read_b64_tr_b16 v[216:217], v7 offset:26624
    ds_read_b64_tr_b16 v[218:219], v7 offset:27648
    ds_read_b64_tr_b16 v[220:221], v8 offset:26624
    ds_read_b64_tr_b16 v[222:223], v8 offset:27648
    ds_read_b64_tr_b16 v[224:225], v7 offset:28672
    ds_read_b64_tr_b16 v[226:227], v7 offset:29696
    ds_read_b64_tr_b16 v[228:229], v8 offset:28672
    ds_read_b64_tr_b16 v[230:231], v8 offset:29696
    ds_read_b64_tr_b16 v[232:233], v7 offset:30720
    ds_read_b64_tr_b16 v[234:235], v7 offset:31744
    ds_read_b64_tr_b16 v[236:237], v8 offset:30720
    ds_read_b64_tr_b16 v[238:239], v8 offset:31744
    v_mov_b32 v10, 159772
    v_mov_b32 v11, 1
    s_mov_b64 exec, 1
    ds_add_u32 v10, v11
    s_mov_b64 exec, -1
    s_waitcnt vmcnt(0)
    v_mov_b32 v5, s3
    s_add_u32 s10, s98, 65536
    s_mov_b64 exec, 1
    buffer_store_dword v5, off, s[28:31], s10
    s_cmp_lg_u32 s77, 0
    s_cbranch_scc1 gf_76
    buffer_store_dword v5, off, s[28:31], s75 sc1
gf_76:
    s_mov_b64 exec, -1
    v_lshlrev_b32 v16, 16, v56
    v_and_b32 v17, 0xffff0000, v56
    v_lshlrev_b32 v18, 16, v57
    v_and_b32 v19, 0xffff0000, v57
    v_lshlrev_b32 v20, 16, v58
    v_and_b32 v21, 0xffff0000, v58
    v_lshlrev_b32 v22, 16, v59
    v_and_b32 v23, 0xffff0000, v59
    v_lshlrev_b32 v24, 16, v60
    v_and_b32 v25, 0xffff0000, v60
    v_lshlrev_b32 v26, 16, v61
    v_and_b32 v27, 0xffff0000, v61
    v_lshlrev_b32 v28, 16, v62
    v_and_b32 v29, 0xffff0000, v62
    v_lshlrev_b32 v30, 16, v63
    v_and_b32 v31, 0xffff0000, v63
    v_add_u32 v244, s56, v2
    v_add_u32 v245, s57, v2
    v_lshrrev_b32 v5, 3, v1
    v_and_b32 v6, 2, v5
    v_lshlrev_b32 v6, 1, v6
    v_xor_b32 v6, v6, v1
    v_and_b32 v6, 7, v6
    v_lshlrev_b32 v6, 4, v6
    v_mul_u32_u24 v5, 1024, v5
    v_add_u32 v6, v6, v5
    s_mov_b32 s43, 0x20000
    s_lshl_b32 s59, s44, 10
    s_sub_u32 s52, s96, 11
    s_cmp_lt_u32 s52, 4
    s_cbranch_scc1 stW_77
    s_cmp_eq_u32 s96, 15
    s_cselect_b32 s52, s97, s96
    s_mov_b64 s[40:41], s[16:17]
    s_mov_b32 s42, 1409024
    s_mov_b32 s53, 2752
    v_lshrrev_b32 v5, 4, v1
    v_lshlrev_b32 v9, 2, v5
    v_xor_b32 v9, v9, v1
    v_and_b32 v9, 15, v9
    v_lshlrev_b32 v9, 4, v9
    v_mul_u32_u24 v5, s53, v5
    v_add_u32 v9, v9, v5
    s_lshl_b32 s58, s52, 8
    s_mul_i32 s52, s44, 11008
    s_add_u32 s58, s58, s52
    s_mov_b32 s56, 44032
    s_add_u32 s59, s59, 32768
    s_mov_b32 s57, 0
    s_branch stD_78
stW_77:
    s_mov_b64 s[40:41], s[8:9]
    s_mov_b32 s42, 524288
    v_mov_b32 v9, v6
    s_and_b32 s53, s97, 1
    s_lshl_b32 s53, s53, 2
    s_add_u32 s52, s52, s53
    s_lshl_b32 s58, s52, 7
    s_lshl_b32 s52, s44, 13
    s_add_u32 s58, s58, s52
    s_mov_b32 s56, 32768
    s_add_u32 s59, s59, 94208
    s_mov_b32 s57, 0
stD_78:
    s_lshl_b32 s60, s46, 14
    s_add_u32 s60, s60, 6291456
    s_add_u32 s61, s60, 4096
    s_add_u32 s62, s60, 8192
    s_add_u32 s63, s60, 12288
    s_waitcnt lgkmcnt(0)
    v_mov_b32 v10, 159772
    s_mov_b32 s10, 0x200000
aw_79:
    ds_read_b32 v11, v10
    s_waitcnt lgkmcnt(0)
    v_cmp_gt_u32 vcc, 4, v11
    s_nop 0
    s_cbranch_vccz aw_done_80
    s_sleep 1
    s_sub_u32 s10, s10, 1
    s_cbranch_scc0 aw_79
aw_done_80:
    s_lshl_b32 s52, s50, 10
    s_add_u32 s53, s52, 896
    v_and_b32 v10, 127, v14
    v_and_b32 v11, 0xffffff80, v14
    v_max_u32 v11, s52, v11
    v_min_u32 v11, s53, v11
    v_add_u32 v246, v10, v11
    v_cmp_ne_u32 s[52:53], v246, v14
    v_lshrrev_b32 v5, 10, v246
    v_cmp_eq_u32 vcc, s50, v5
    v_add_u32 v5, 20865024, v246
    v_lshlrev_b32 v10, 5, v246
    v_add_u32 v10, 20971520, v10
    v_cndmask_b32 v11, v10, v5, vcc
    v_mov_b32 v246, v14
    v_lshrrev_b32 v5, 10, v246
    v_cmp_eq_u32 vcc, s50, v5
    v_add_u32 v5, 20865024, v246
    v_lshlrev_b32 v14, 5, v246
    v_add_u32 v14, 20971520, v14
    v_cndmask_b32 v15, v14, v5, vcc
    s_mov_b32 s10, 0x3fffe
poll_82:
    s_and_b32 vcc_lo, s10, 15
    s_cbranch_scc0 poll_82_g
    buffer_load_dword v5, v11, s[28:31], 0 offen sc1
poll_chk_84:
    s_waitcnt vmcnt(0)
    v_cmp_ne_u32 vcc, s3, v5
    s_nop 0
    s_cbranch_vccz poll_done_83
    s_sleep 2
    s_sub_u32 s10, s10, 1
    s_cbranch_scc0 poll_82
    s_branch poll_done_83
poll_82_g:
    buffer_load_dword v5, v10, s[28:31], 0 offen sc1
    s_branch poll_chk_84
poll_done_83:
    s_cmp_eq_u64 s[52:53], 0
    s_cbranch_scc1 h_loc_81
    s_mov_b32 s10, 0x3fffe
poll_85:
    s_and_b32 vcc_lo, s10, 15
    s_cbranch_scc0 poll_85_g
    buffer_load_dword v5, v15, s[28:31], 0 offen sc1
poll_chk_87:
    s_waitcnt vmcnt(0)
    v_cmp_ne_u32 vcc, s3, v5
    s_nop 0
    s_cbranch_vccz poll_done_86
    s_sleep 2
    s_sub_u32 s10, s10, 1
    s_cbranch_scc0 poll_85
    s_branch poll_done_86
poll_85_g:
    buffer_load_dword v5, v14, s[28:31], 0 offen sc1
    s_branch poll_chk_87
poll_done_86:
h_loc_81:
    buffer_load_dwordx4 v[48:51], v12, s[28:31], s60 offen offset:0 sc1
    buffer_load_dwordx4 v[52:55], v12, s[28:31], s60 offen offset:1024 sc1
    buffer_load_dwordx4 v[56:59], v12, s[28:31], s60 offen offset:2048 sc1
    buffer_load_dwordx4 v[60:63], v12, s[28:31], s60 offen offset:3072 sc1
    buffer_load_dwordx4 v[64:67], v12, s[28:31], s61 offen offset:0 sc1
    buffer_load_dwordx4 v[68:71], v12, s[28:31], s61 offen offset:1024 sc1
    buffer_load_dwordx4 v[72:75], v12, s[28:31], s61 offen offset:2048 sc1
    buffer_load_dwordx4 v[76:79], v12, s[28:31], s61 offen offset:3072 sc1
    buffer_load_dwordx4 v[80:83], v13, s[28:31], s62 offen offset:0 sc1
    buffer_load_dwordx4 v[84:87], v13, s[28:31], s62 offen offset:1024 sc1
    buffer_load_dwordx4 v[88:91], v13, s[28:31], s62 offen offset:2048 sc1
    buffer_load_dwordx4 v[92:95], v13, s[28:31], s62 offen offset:3072 sc1
    buffer_load_dwordx4 v[96:99], v13, s[28:31], s63 offen offset:0 sc1
    buffer_load_dwordx4 v[100:103], v13, s[28:31], s63 offen offset:1024 sc1
    buffer_load_dwordx4 v[104:107], v13, s[28:31], s63 offen offset:2048 sc1
    buffer_load_dwordx4 v[108:111], v13, s[28:31], s63 offen offset:3072 sc1
    s_mov_b32 m0, s59
    s_add_u32 s59, s59, 4096
    buffer_load_dwordx4 v9, s[40:43], s58 offen lds
    s_add_u32 s58, s58, s56
    s_mov_b32 m0, s59
    s_add_u32 s59, s59, 4096
    buffer_load_dwordx4 v9, s[40:43], s58 offen lds
    s_add_u32 s58, s58, s56
    s_mov_b32 m0, s59
    s_add_u32 s59, s59, 4096
    buffer_load_dwordx4 v9, s[40:43], s58 offen lds
    s_add_u32 s58, s58, s56
    s_mov_b32 m0, s59
    s_add_u32 s59, s59, 4096
    buffer_load_dwordx4 v9, s[40:43], s58 offen lds
    s_add_u32 s58, s58, s56
    s_mov_b32 m0, s59
    s_add_u32 s59, s59, 4096
    buffer_load_dwordx4 v9, s[40:43], s58 offen lds
    s_add_u32 s58, s58, s56
    s_mov_b32 m0, s59
    s_add_u32 s59, s59, 4096
    buffer_load_dwordx4 v9, s[40:43], s58 offen lds
    s_add_u32 s58, s58, s56
    s_mov_b32 m0, s59
    s_add_u32 s59, s59, 4096
    buffer_load_dwordx4 v9, s[40:43], s58 offen lds
    s_add_u32 s58, s58, s56
    s_mov_b32 m0, s59
    s_add_u32 s59, s59, 4096
    buffer_load_dwordx4 v9, s[40:43], s58 offen lds
    s_add_u32 s58, s58, s56
    s_lshl_b32 s52, s49, 15
    s_lshl_b32 s53, s48, 12
    s_add_u32 s52, s52, s53
    s_lshl_b32 s53, s46, 11
    s_add_u32 s52, s52, s53
    s_add_u32 s52, s52, 8388608
    v_lshlrev_b32 v5, 3, v3
    s_lshl_b32 s55, s49, 4
    s_lshl_b32 s53, s48, 1
    s_add_u32 s53, s53, s46
    s_add_u32 s55, s55, s53
    s_lshl_b32 s55, s55, 8
    s_add_u32 s55, s55, 20316160
    s_lshl_b32 s54, s49, 7
    s_lshl_b32 s53, s53, 2
    s_add_u32 s54, s54, s53
    s_add_u32 s54, s54, 20783104
    s_waitcnt vmcnt(23)
    v_mfma_f32_32x32x16_bf16 v[32:47], v[116:119], v[48:51], 0
    v_mfma_f32_32x32x16_bf16 v[16:31], v[112:115], v[48:51], v[16:31]
    s_waitcnt vmcnt(22)
    v_mfma_f32_32x32x16_bf16 v[32:47], v[124:127], v[52:55], v[32:47]
    v_mfma_f32_32x32x16_bf16 v[16:31], v[120:123], v[52:55], v[16:31]
    s_waitcnt vmcnt(21)
    v_mfma_f32_32x32x16_bf16 v[32:47], v[132:135], v[56:59], v[32:47]
    v_mfma_f32_32x32x16_bf16 v[16:31], v[128:131], v[56:59], v[16:31]
    s_waitcnt vmcnt(20)
    v_mfma_f32_32x32x16_bf16 v[32:47], v[140:143], v[60:63], v[32:47]
    v_mfma_f32_32x32x16_bf16 v[16:31], v[136:139], v[60:63], v[16:31]
    s_waitcnt vmcnt(19)
    v_mfma_f32_32x32x16_bf16 v[32:47], v[148:151], v[64:67], v[32:47]
    v_mfma_f32_32x32x16_bf16 v[16:31], v[144:147], v[64:67], v[16:31]
    s_waitcnt vmcnt(18)
    v_mfma_f32_32x32x16_bf16 v[32:47], v[156:159], v[68:71], v[32:47]
    v_mfma_f32_32x32x16_bf16 v[16:31], v[152:155], v[68:71], v[16:31]
    s_waitcnt vmcnt(17)
    v_mfma_f32_32x32x16_bf16 v[32:47], v[164:167], v[72:75], v[32:47]
    v_mfma_f32_32x32x16_bf16 v[16:31], v[160:163], v[72:75], v[16:31]
    s_waitcnt vmcnt(16)
    v_mfma_f32_32x32x16_bf16 v[32:47], v[172:175], v[76:79], v[32:47]
    v_mfma_f32_32x32x16_bf16 v[16:31], v[168:171], v[76:79], v[16:31]
    s_waitcnt vmcnt(15)
    v_mfma_f32_32x32x16_bf16 v[32:47], v[180:183], v[80:83], v[32:47]
    v_mfma_f32_32x32x16_bf16 v[16:31], v[176:179], v[80:83], v[16:31]
    s_waitcnt vmcnt(14)
    v_mfma_f32_32x32x16_bf16 v[32:47], v[188:191], v[84:87], v[32:47]
    v_mfma_f32_32x32x16_bf16 v[16:31], v[184:187], v[84:87], v[16:31]
    s_waitcnt vmcnt(13)
    v_mfma_f32_32x32x16_bf16 v[32:47], v[196:199], v[88:91], v[32:47]
    v_mfma_f32_32x32x16_bf16 v[16:31], v[192:195], v[88:91], v[16:31]
    s_waitcnt vmcnt(12)
    v_mfma_f32_32x32x16_bf16 v[32:47], v[204:207], v[92:95], v[32:47]
    v_mfma_f32_32x32x16_bf16 v[16:31], v[200:203], v[92:95], v[16:31]
    s_waitcnt vmcnt(11)
    v_mfma_f32_32x32x16_bf16 v[32:47], v[212:215], v[96:99], v[32:47]
    v_mfma_f32_32x32x16_bf16 v[16:31], v[208:211], v[96:99], v[16:31]
    s_waitcnt vmcnt(10)
    v_mfma_f32_32x32x16_bf16 v[32:47], v[220:223], v[100:103], v[32:47]
    v_mfma_f32_32x32x16_bf16 v[16:31], v[216:219], v[100:103], v[16:31]
    s_waitcnt vmcnt(9)
    v_mfma_f32_32x32x16_bf16 v[32:47], v[228:231], v[104:107], v[32:47]
    v_mfma_f32_32x32x16_bf16 v[16:31], v[224:227], v[104:107], v[16:31]
    s_waitcnt vmcnt(8)
    v_mfma_f32_32x32x16_bf16 v[32:47], v[236:239], v[108:111], v[32:47]
    v_mfma_f32_32x32x16_bf16 v[16:31], v[232:235], v[108:111], v[16:31]
    s_nop 10
    ds_write_b128 v244, v[32:35] offset:0
    ds_write_b128 v244, v[36:39] offset:1024
    ds_write_b128 v244, v[40:43] offset:2048
    ds_write_b128 v244, v[44:47] offset:3072
    v_mov_b32 v10, 159744
    v_mov_b32 v11, 1
    s_mov_b64 exec, 1
    ds_add_u32 v10, v11
    s_mov_b64 exec, -1
    v_mov_b32 v10, 159744
    s_mov_b32 s10, 0x200000
aw_88:
    ds_read_b32 v11, v10
    s_waitcnt lgkmcnt(0)
    v_cmp_gt_u32 vcc, 4, v11
    s_nop 0
    s_cbranch_vccz aw_done_89
    s_sleep 1
    s_sub_u32 s10, s10, 1
    s_cbranch_scc0 aw_88
aw_done_89:
    ds_read_b128 v[128:131], v245 offset:0
    ds_read_b128 v[132:135], v245 offset:1024
    ds_read_b128 v[136:139], v245 offset:2048
    ds_read_b128 v[140:143], v245 offset:3072
    s_waitcnt lgkmcnt(0)
    v_pk_add_f32 v[16:17], v[16:17], v[128:129]
    v_pk_add_f32 v[18:19], v[18:19], v[130:131]
    v_pk_add_f32 v[20:21], v[20:21], v[132:133]
    v_pk_add_f32 v[22:23], v[22:23], v[134:135]
    v_pk_add_f32 v[24:25], v[24:25], v[136:137]
    v_pk_add_f32 v[26:27], v[26:27], v[138:139]
    v_pk_add_f32 v[28:29], v[28:29], v[140:141]
    v_pk_add_f32 v[30:31], v[30:31], v[142:143]
    v_cvt_pk_bf16_f32 v248, v16, v17
    v_cvt_pk_bf16_f32 v249, v18, v19
    v_cvt_pk_bf16_f32 v250, v20, v21
    v_cvt_pk_bf16_f32 v251, v22, v23
    v_cvt_pk_bf16_f32 v252, v24, v25
    v_cvt_pk_bf16_f32 v253, v26, v27
    v_cvt_pk_bf16_f32 v254, v28, v29
    v_cvt_pk_bf16_f32 v255, v30, v31
    buffer_store_dwordx4 v[248:251], v2, s[28:31], s52 offen sc1
    buffer_store_dwordx4 v[252:255], v2, s[28:31], s52 offen offset:1024 sc1
    v_pk_mul_f32 v[218:219], v[16:17], v[16:17]
    v_pk_add_f32 v[216:217], v[16:17], v[18:19]
    v_pk_fma_f32 v[218:219], v[18:19], v[18:19], v[218:219]
    v_pk_add_f32 v[216:217], v[216:217], v[20:21]
    v_pk_fma_f32 v[218:219], v[20:21], v[20:21], v[218:219]
    v_pk_add_f32 v[216:217], v[216:217], v[22:23]
    v_pk_fma_f32 v[218:219], v[22:23], v[22:23], v[218:219]
    v_pk_add_f32 v[216:217], v[216:217], v[24:25]
    v_pk_fma_f32 v[218:219], v[24:25], v[24:25], v[218:219]
    v_pk_add_f32 v[216:217], v[216:217], v[26:27]
    v_pk_fma_f32 v[218:219], v[26:27], v[26:27], v[218:219]
    v_pk_add_f32 v[216:217], v[216:217], v[28:29]
    v_pk_fma_f32 v[218:219], v[28:29], v[28:29], v[218:219]
    v_pk_add_f32 v[216:217], v[216:217], v[30:31]
    v_pk_fma_f32 v[218:219], v[30:31], v[30:31], v[218:219]
    v_add_f32 v216, v216, v217
    v_add_f32 v217, v218, v219
    v_mov_b32 v220, v216
    s_nop 1
    v_permlane32_swap_b32 v216, v220
    v_add_f32 v216, v216, v220
    v_mov_b32 v221, v217
    s_nop 1
    v_permlane32_swap_b32 v217, v221
    v_add_f32 v217, v217, v221
    s_mov_b32 exec_hi, 0
    buffer_store_dwordx2 v[216:217], v5, s[28:31], s55 offen sc1
    s_mov_b64 exec, -1
    v_mov_b32 v10, 159744
    v_mov_b32 v11, 1
    s_mov_b64 exec, 1
    ds_add_u32 v10, v11
    s_mov_b64 exec, -1
    s_mov_b32 m0, s59
    s_add_u32 s59, s59, 4096
    buffer_load_dwordx4 v9, s[40:43], s58 offen lds
    s_add_u32 s58, s58, s56
    s_mov_b32 m0, s59
    s_add_u32 s59, s59, 4096
    buffer_load_dwordx4 v9, s[40:43], s58 offen lds
    s_add_u32 s58, s58, s56
    s_mov_b32 m0, s59
    s_add_u32 s59, s59, 4096
    buffer_load_dwordx4 v9, s[40:43], s58 offen lds
    s_add_u32 s58, s58, s56
    s_mov_b32 m0, s59
    s_add_u32 s59, s59, 4096
    buffer_load_dwordx4 v9, s[40:43], s58 offen lds
    s_add_u32 s58, s58, s56
    s_waitcnt vmcnt(4)
    v_mov_b32 v5, s3
    s_add_u32 s10, s54, 65536
    s_mov_b64 exec, 1
    buffer_store_dword v5, off, s[28:31], s10
    s_mov_b64 exec, -1
    s_mov_b32 s11, s54
    v_mov_b32 v10, 159784
    v_mov_b32 v11, 1
    s_mov_b64 exec, 1
    ds_add_u32 v10, v11
    s_mov_b64 exec, -1
    s_cmp_ge_u32 s96, 11
    s_cbranch_scc1 P3wo_91
    s_mov_b32 m0, s59
    s_add_u32 s59, s59, 4096
    buffer_load_dwordx4 v9, s[40:43], s58 offen lds
    s_add_u32 s58, s58, s56
    s_mov_b32 m0, s59
    s_add_u32 s59, s59, 4096
    buffer_load_dwordx4 v9, s[40:43], s58 offen lds
    s_add_u32 s58, s58, s56
    s_mov_b32 m0, s59
    s_add_u32 s59, s59, 4096
    buffer_load_dwordx4 v9, s[40:43], s58 offen lds
    s_add_u32 s58, s58, s56
    s_mov_b32 m0, s59
    s_add_u32 s59, s59, 4096
    buffer_load_dwordx4 v9, s[40:43], s58 offen lds
    s_add_u32 s58, s58, s56
    s_mov_b32 m0, s59
    s_add_u32 s59, s59, 4096
    buffer_load_dwordx4 v9, s[40:43], s58 offen lds
    s_add_u32 s58, s58, s56
    s_mov_b32 m0, s59
    s_add_u32 s59, s59, 4096
    buffer_load_dwordx4 v9, s[40:43], s58 offen lds
    s_add_u32 s58, s58, s56
    s_mov_b32 m0, s59
    s_add_u32 s59, s59, 4096
    buffer_load_dwordx4 v9, s[40:43], s58 offen lds
    s_add_u32 s58, s58, s56
    s_mov_b32 m0, s59
    s_add_u32 s59, s59, 4096
    buffer_load_dwordx4 v9, s[40:43], s58 offen lds
    s_add_u32 s58, s58, s56
    s_lshl_b32 s98, s97, 2
    s_add_u32 s98, s98, s44
    s_lshl_b32 s63, s98, 7
    s_add_u32 s66, s63, 20783104
    v_and_b32 v7, 15, v1
    v_lshlrev_b32 v7, 2, v7
    v_add_u32 v8, 65536, v7
    v_bfe_u32 v5, v1, 2, 2
    v_lshlrev_b32 v12, 2, v4
    v_add_u32 v12, v12, v5
    v_lshlrev_b32 v12, 8, v12
    v_lshl_add_u32 v12, v5, 6, v12
    v_bfe_u32 v5, v1, 4, 1
    v_lshl_add_u32 v12, v5, 5, v12
    v_and_b32 v5, 3, v1
    v_lshl_add_u32 v12, v5, 3, v12
    v_xor_b32 v13, 64, v12
    v_xor_b32 v14, 128, v12
    v_xor_b32 v15, 192, v12
    s_lshl_b32 s60, s98, 15
    s_add_u32 s60, s60, 8388608
    s_lshl_b32 s52, s96, 2
    s_add_u32 s63, s63, s52
    s_add_u32 s63, s63, 20791296
    s_lshl_b32 s61, s98, 12
    s_add_u32 s61, s61, 20316160
    s_lshl_b32 s62, s96, 11
    s_add_u32 s62, s62, 20643840
    s_mul_i32 s68, s98, 88064
    s_lshl_b32 s52, s96, 13
    s_add_u32 s68, s68, s52
    s_add_u32 s68, s68, 14680064
    s_add_u32 s69, s68, 4096
    buffer_load_dword v5, v8, s[28:31], s66 offen sc1
    s_waitcnt vmcnt(0)
    v_cmp_ne_u32 vcc, s3, v5
    v_mov_b32 v10, 159752
    v_mov_b32 v11, 1
    s_mov_b64 exec, 1
    ds_add_u32 v10, v11
    s_mov_b64 exec, -1
    s_cbranch_vccz poll_done_94
    s_mov_b32 s10, 0x3fffe
poll_93:
    s_and_b32 vcc_lo, s10, 15
    s_cbranch_scc0 poll_93_g
    buffer_load_dword v5, v8, s[28:31], s66 offen sc1
poll_chk_95:
    s_waitcnt vmcnt(0)
    v_cmp_ne_u32 vcc, s3, v5
    s_nop 0
    s_cbranch_vccz poll_done_94
    s_sleep 2
    s_sub_u32 s10, s10, 1
    s_cbranch_scc0 poll_93
    s_branch poll_done_94
poll_93_g:
    v_mov_b32 v5, s3
    s_mov_b64 exec, 1
    s_cmp_lg_u32 s2, 0
    s_cbranch_scc1 gf_96
    buffer_store_dword v5, off, s[28:31], s11 sc1
gf_96:
    s_mov_b64 exec, -1
    buffer_load_dword v5, v7, s[28:31], s66 offen sc1
    s_branch poll_chk_95
poll_done_94:
    buffer_load_dwordx4 v[128:131], v2, s[28:31], s60 offen offset:0 sc1
    buffer_load_dwordx4 v[132:135], v2, s[28:31], s60 offen offset:1024 sc1
    buffer_load_dwordx4 v[136:139], v2, s[28:31], s60 offen offset:2048 sc1
    buffer_load_dwordx4 v[140:143], v2, s[28:31], s60 offen offset:3072 sc1
    s_add_u32 s60, s60, 4096
    buffer_load_dwordx4 v[144:147], v2, s[28:31], s60 offen offset:0 sc1
    buffer_load_dwordx4 v[148:151], v2, s[28:31], s60 offen offset:1024 sc1
    buffer_load_dwordx4 v[152:155], v2, s[28:31], s60 offen offset:2048 sc1
    buffer_load_dwordx4 v[156:159], v2, s[28:31], s60 offen offset:3072 sc1
    s_add_u32 s60, s60, 4096
    buffer_load_dwordx4 v[160:163], v2, s[28:31], s60 offen offset:0 sc1
    buffer_load_dwordx4 v[164:167], v2, s[28:31], s60 offen offset:1024 sc1
    v_mov_b32 v5, s3
    s_mov_b64 exec, 1
    s_cmp_lg_u32 s2, 0
    s_cbranch_scc1 gf_97
    buffer_store_dword v5, off, s[28:31], s11 sc1
gf_97:
    s_mov_b64 exec, -1
    v_mov_b32 v10, 159752
    s_mov_b32 s10, 0x200000
aw_98:
    ds_read_b32 v11, v10
    s_waitcnt lgkmcnt(0)
    v_cmp_gt_u32 vcc, 4, v11
    s_nop 0
    s_cbranch_vccz aw_done_99
    s_sleep 1
    s_sub_u32 s10, s10, 1
    s_cbranch_scc0 aw_98
aw_done_99:
    s_setprio 0
    s_mov_b32 s10, 0x200000
aw_100:
    v_mov_b32 v10, 159744
    ds_read_b64 v[10:11], v10
    s_waitcnt lgkmcnt(0)
    v_cmp_gt_u32 vcc, 8, v10
    v_cmp_gt_u32 s[54:55], 4, v11
    s_nop 0
    s_or_b64 vcc, vcc, s[54:55]
    s_cbranch_vccz aw_done_101
    s_sleep 1
    s_sub_u32 s10, s10, 1
    s_cbranch_scc0 aw_100
aw_done_101:
    ds_read_b64_tr_b16 v[16:17], v12 offset:32768
    ds_read_b64_tr_b16 v[18:19], v12 offset:34816
    ds_read_b64_tr_b16 v[20:21], v13 offset:32768
    ds_read_b64_tr_b16 v[22:23], v13 offset:34816
    ds_read_b64_tr_b16 v[24:25], v14 offset:32768
    ds_read_b64_tr_b16 v[26:27], v14 offset:34816
    ds_read_b64_tr_b16 v[28:29], v15 offset:32768
    ds_read_b64_tr_b16 v[30:31], v15 offset:34816
    ds_read_b64_tr_b16 v[32:33], v12 offset:36864
    ds_read_b64_tr_b16 v[34:35], v12 offset:38912
    ds_read_b64_tr_b16 v[36:37], v13 offset:36864
    ds_read_b64_tr_b16 v[38:39], v13 offset:38912
    ds_read_b64_tr_b16 v[40:41], v14 offset:36864
    ds_read_b64_tr_b16 v[42:43], v14 offset:38912
    ds_read_b64_tr_b16 v[44:45], v15 offset:36864
    ds_read_b64_tr_b16 v[46:47], v15 offset:38912
    v_lshlrev_b32 v5, 3, v1
    s_waitcnt vmcnt(9) lgkmcnt(8)
    v_mfma_f32_32x32x16_bf16 v[64:79], v[16:19], v[128:131], 0
    ds_read_b64_tr_b16 v[48:49], v12 offset:40960
    ds_read_b64_tr_b16 v[50:51], v12 offset:43008
    buffer_load_dwordx4 v[168:171], v2, s[28:31], s60 offen offset:2048 sc1
    v_mfma_f32_32x32x16_bf16 v[80:95], v[20:23], v[128:131], 0
    ds_read_b64_tr_b16 v[52:53], v13 offset:40960
    ds_read_b64_tr_b16 v[54:55], v13 offset:43008
    v_mfma_f32_32x32x16_bf16 v[96:111], v[24:27], v[128:131], 0
    ds_read_b64_tr_b16 v[56:57], v14 offset:40960
    ds_read_b64_tr_b16 v[58:59], v14 offset:43008
    s_mov_b32 m0, s59
    s_add_u32 s59, s59, 4096
    buffer_load_dwordx4 v9, s[40:43], s58 offen lds
    s_add_u32 s58, s58, s56
    v_mfma_f32_32x32x16_bf16 v[112:127], v[28:31], v[128:131], 0
    ds_read_b64_tr_b16 v[60:61], v15 offset:40960
    ds_read_b64_tr_b16 v[62:63], v15 offset:43008
    s_waitcnt vmcnt(10) lgkmcnt(8)
    v_mfma_f32_32x32x16_bf16 v[64:79], v[32:35], v[132:135], v[64:79]
    ds_read_b64_tr_b16 v[16:17], v12 offset:45056
    ds_read_b64_tr_b16 v[18:19], v12 offset:47104
    buffer_load_dwordx4 v[172:175], v2, s[28:31], s60 offen offset:3072 sc1
    s_add_u32 s60, s60, 4096
    v_mfma_f32_32x32x16_bf16 v[80:95], v[36:39], v[132:135], v[80:95]
    ds_read_b64_tr_b16 v[20:21], v13 offset:45056
    ds_read_b64_tr_b16 v[22:23], v13 offset:47104
    v_mfma_f32_32x32x16_bf16 v[96:111], v[40:43], v[132:135], v[96:111]
    ds_read_b64_tr_b16 v[24:25], v14 offset:45056
    ds_read_b64_tr_b16 v[26:27], v14 offset:47104
    s_mov_b32 m0, s59
    s_add_u32 s59, s59, 4096
    buffer_load_dwordx4 v9, s[40:43], s58 offen lds
    s_add_u32 s58, s58, s56
    v_mfma_f32_32x32x16_bf16 v[112:127], v[44:47], v[132:135], v[112:127]
    ds_read_b64_tr_b16 v[28:29], v15 offset:45056
    ds_read_b64_tr_b16 v[30:31], v15 offset:47104
    s_waitcnt vmcnt(11) lgkmcnt(8)
    v_mfma_f32_32x32x16_bf16 v[64:79], v[48:51], v[136:139], v[64:79]
    ds_read_b64_tr_b16 v[32:33], v12 offset:49152
    ds_read_b64_tr_b16 v[34:35], v12 offset:51200
    buffer_load_dwordx4 v[176:179], v2, s[28:31], s60 offen offset:0 sc1
    v_mfma_f32_32x32x16_bf16 v[80:95], v[52:55], v[136:139], v[80:95]
    ds_read_b64_tr_b16 v[36:37], v13 offset:49152
    ds_read_b64_tr_b16 v[38:39], v13 offset:51200
    v_mfma_f32_32x32x16_bf16 v[96:111], v[56:59], v[136:139], v[96:111]
    ds_read_b64_tr_b16 v[40:41], v14 offset:49152
    ds_read_b64_tr_b16 v[42:43], v14 offset:51200
    s_mov_b32 m0, s59
    s_add_u32 s59, s59, 4096
    buffer_load_dwordx4 v9, s[40:43], s58 offen lds
    s_add_u32 s58, s58, s56
    v_mfma_f32_32x32x16_bf16 v[112:127], v[60:63], v[136:139], v[112:127]
    ds_read_b64_tr_b16 v[44:45], v15 offset:49152
    ds_read_b64_tr_b16 v[46:47], v15 offset:51200
    s_waitcnt vmcnt(12) lgkmcnt(8)
    v_mfma_f32_32x32x16_bf16 v[64:79], v[16:19], v[140:143], v[64:79]
    ds_read_b64_tr_b16 v[48:49], v12 offset:53248
    ds_read_b64_tr_b16 v[50:51], v12 offset:55296
    buffer_load_dwordx4 v[180:183], v2, s[28:31], s60 offen offset:1024 sc1
    v_mfma_f32_32x32x16_bf16 v[80:95], v[20:23], v[140:143], v[80:95]
    ds_read_b64_tr_b16 v[52:53], v13 offset:53248
    ds_read_b64_tr_b16 v[54:55], v13 offset:55296
    v_mfma_f32_32x32x16_bf16 v[96:111], v[24:27], v[140:143], v[96:111]
    ds_read_b64_tr_b16 v[56:57], v14 offset:53248
    ds_read_b64_tr_b16 v[58:59], v14 offset:55296
    s_mov_b32 m0, s59
    s_add_u32 s59, s59, 4096
    buffer_load_dwordx4 v9, s[40:43], s58 offen lds
    s_add_u32 s58, s58, s56
    v_mfma_f32_32x32x16_bf16 v[112:127], v[28:31], v[140:143], v[112:127]
    ds_read_b64_tr_b16 v[60:61], v15 offset:53248
    ds_read_b64_tr_b16 v[62:63], v15 offset:55296
    s_waitcnt vmcnt(13) lgkmcnt(8)
    v_mfma_f32_32x32x16_bf16 v[64:79], v[32:35], v[144:147], v[64:79]
    v_add_u32 v12, 0xe000, v12
    v_add_u32 v13, 0xe000, v13
    v_add_u32 v14, 0xe000, v14
    v_add_u32 v15, 0xe000, v15
    ds_read_b64_tr_b16 v[16:17], v12 offset:0
    ds_read_b64_tr_b16 v[18:19], v12 offset:2048
    buffer_load_dwordx4 v[184:187], v2, s[28:31], s60 offen offset:2048 sc1
    v_mfma_f32_32x32x16_bf16 v[80:95], v[36:39], v[144:147], v[80:95]
    ds_read_b64_tr_b16 v[20:21], v13 offset:0
    ds_read_b64_tr_b16 v[22:23], v13 offset:2048
    v_mfma_f32_32x32x16_bf16 v[96:111], v[40:43], v[144:147], v[96:111]
    ds_read_b64_tr_b16 v[24:25], v14 offset:0
    ds_read_b64_tr_b16 v[26:27], v14 offset:2048
    s_mov_b32 m0, s59
    s_add_u32 s59, s59, 4096
    buffer_load_dwordx4 v9, s[40:43], s58 offen lds
    s_add_u32 s58, s58, s56
    v_mfma_f32_32x32x16_bf16 v[112:127], v[44:47], v[144:147], v[112:127]
    ds_read_b64_tr_b16 v[28:29], v15 offset:0
    ds_read_b64_tr_b16 v[30:31], v15 offset:2048
    s_waitcnt vmcnt(14) lgkmcnt(8)
    v_mfma_f32_32x32x16_bf16 v[64:79], v[48:51], v[148:151], v[64:79]
    ds_read_b64_tr_b16 v[32:33], v12 offset:4096
    ds_read_b64_tr_b16 v[34:35], v12 offset:6144
    buffer_load_dwordx4 v[188:191], v2, s[28:31], s60 offen offset:3072 sc1
    s_add_u32 s60, s60, 4096
    v_mfma_f32_32x32x16_bf16 v[80:95], v[52:55], v[148:151], v[80:95]
    ds_read_b64_tr_b16 v[36:37], v13 offset:4096
    ds_read_b64_tr_b16 v[38:39], v13 offset:6144
    v_mfma_f32_32x32x16_bf16 v[96:111], v[56:59], v[148:151], v[96:111]
    ds_read_b64_tr_b16 v[40:41], v14 offset:4096
    ds_read_b64_tr_b16 v[42:43], v14 offset:6144
    s_mov_b32 m0, s59
    s_add_u32 s59, s59, 4096
    buffer_load_dwordx4 v9, s[40:43], s58 offen lds
    s_add_u32 s58, s58, s56
    v_mfma_f32_32x32x16_bf16 v[112:127], v[60:63], v[148:151], v[112:127]
    ds_read_b64_tr_b16 v[44:45], v15 offset:4096
    ds_read_b64_tr_b16 v[46:47], v15 offset:6144
    s_waitcnt vmcnt(15) lgkmcnt(8)
    v_mfma_f32_32x32x16_bf16 v[64:79], v[16:19], v[152:155], v[64:79]
    ds_read_b64_tr_b16 v[48:49], v12 offset:8192
    ds_read_b64_tr_b16 v[50:51], v12 offset:10240
    buffer_load_dwordx4 v[192:195], v2, s[28:31], s60 offen offset:0 sc1
    v_mfma_f32_32x32x16_bf16 v[80:95], v[20:23], v[152:155], v[80:95]
    ds_read_b64_tr_b16 v[52:53], v13 offset:8192
    ds_read_b64_tr_b16 v[54:55], v13 offset:10240
    v_mov_b32 v128, 0
    v_mov_b32 v129, 0
    v_mov_b64 v[130:131], v[128:129]
    v_mov_b64 v[132:133], v[128:129]
    v_mov_b64 v[134:135], v[128:129]
    v_mfma_f32_32x32x16_bf16 v[96:111], v[24:27], v[152:155], v[96:111]
    ds_read_b64_tr_b16 v[56:57], v14 offset:8192
    ds_read_b64_tr_b16 v[58:59], v14 offset:10240
    s_mov_b32 m0, s59
    s_add_u32 s59, s59, 4096
    buffer_load_dwordx4 v9, s[40:43], s58 offen lds
    s_add_u32 s58, s58, s56
    v_mfma_f32_32x32x16_bf16 v[112:127], v[28:31], v[152:155], v[112:127]
    ds_read_b64_tr_b16 v[60:61], v15 offset:8192
    ds_read_b64_tr_b16 v[62:63], v15 offset:10240
    v_mov_b64 v[136:137], v[128:129]
    v_mov_b64 v[138:139], v[128:129]
    v_mov_b64 v[140:141], v[128:129]
    v_mov_b64 v[142:143], v[128:129]
    s_waitcnt vmcnt(16) lgkmcnt(8)
    v_mfma_f32_32x32x16_bf16 v[64:79], v[32:35], v[156:159], v[64:79]
    ds_read_b64_tr_b16 v[16:17], v12 offset:12288
    ds_read_b64_tr_b16 v[18:19], v12 offset:14336
    buffer_load_dwordx4 v[196:199], v2, s[28:31], s60 offen offset:1024 sc1
    v_mfma_f32_32x32x16_bf16 v[80:95], v[36:39], v[156:159], v[80:95]
    ds_read_b64_tr_b16 v[20:21], v13 offset:12288
    ds_read_b64_tr_b16 v[22:23], v13 offset:14336
    v_mfma_f32_32x32x16_bf16 v[96:111], v[40:43], v[156:159], v[96:111]
    ds_read_b64_tr_b16 v[24:25], v14 offset:12288
    ds_read_b64_tr_b16 v[26:27], v14 offset:14336
    s_mov_b32 m0, s59
    s_add_u32 s59, s59, 4096
    buffer_load_dwordx4 v9, s[40:43], s58 offen lds
    s_add_u32 s58, s58, s56
    v_mfma_f32_32x32x16_bf16 v[112:127], v[44:47], v[156:159], v[112:127]
    ds_read_b64_tr_b16 v[28:29], v15 offset:12288
    ds_read_b64_tr_b16 v[30:31], v15 offset:14336
    v_mov_b32 v10, 159808
    v_mov_b32 v11, 1
    s_mov_b64 exec, 1
    ds_add_u32 v10, v11
    s_mov_b64 exec, -1
    s_waitcnt vmcnt(17) lgkmcnt(9)
    v_mfma_f32_32x32x16_bf16 v[64:79], v[48:51], v[160:163], v[64:79]
    ds_read_b64_tr_b16 v[32:33], v12 offset:16384
    ds_read_b64_tr_b16 v[34:35], v12 offset:18432
    buffer_load_dwordx4 v[200:203], v2, s[28:31], s60 offen offset:2048 sc1
    v_mfma_f32_32x32x16_bf16 v[80:95], v[52:55], v[160:163], v[80:95]
    ds_read_b64_tr_b16 v[36:37], v13 offset:16384
    ds_read_b64_tr_b16 v[38:39], v13 offset:18432
    v_mfma_f32_32x32x16_bf16 v[96:111], v[56:59], v[160:163], v[96:111]
    ds_read_b64_tr_b16 v[40:41], v14 offset:16384
    ds_read_b64_tr_b16 v[42:43], v14 offset:18432
    s_mov_b32 m0, s59
    s_add_u32 s59, s59, 4096
    buffer_load_dwordx4 v9, s[40:43], s58 offen lds
    s_add_u32 s58, s58, s56
    v_mfma_f32_32x32x16_bf16 v[112:127], v[60:63], v[160:163], v[112:127]
    ds_read_b64_tr_b16 v[44:45], v15 offset:16384
    ds_read_b64_tr_b16 v[46:47], v15 offset:18432
    s_waitcnt vmcnt(18) lgkmcnt(9)
    v_mfma_f32_32x32x16_bf16 v[64:79], v[16:19], v[164:167], v[64:79]
    ds_read_b64_tr_b16 v[48:49], v12 offset:20480
    ds_read_b64_tr_b16 v[50:51], v12 offset:22528
    buffer_load_dwordx4 v[204:207], v2, s[28:31], s60 offen offset:3072 sc1
    s_add_u32 s60, s60, 4096
    v_mfma_f32_32x32x16_bf16 v[80:95], v[20:23], v[164:167], v[80:95]
    ds_read_b64_tr_b16 v[52:53], v13 offset:20480
    ds_read_b64_tr_b16 v[54:55], v13 offset:22528
    v_mfma_f32_32x32x16_bf16 v[96:111], v[24:27], v[164:167], v[96:111]
    ds_read_b64_tr_b16 v[56:57], v14 offset:20480
    ds_read_b64_tr_b16 v[58:59], v14 offset:22528
    s_mov_b32 m0, s59
    s_add_u32 s59, s59, 4096
    buffer_load_dwordx4 v9, s[40:43], s58 offen lds
    s_add_u32 s58, s58, s56
    v_mfma_f32_32x32x16_bf16 v[112:127], v[28:31], v[164:167], v[112:127]
    ds_read_b64_tr_b16 v[60:61], v15 offset:20480
    ds_read_b64_tr_b16 v[62:63], v15 offset:22528
    s_waitcnt vmcnt(19) lgkmcnt(8)
    v_mfma_f32_32x32x16_bf16 v[64:79], v[32:35], v[168:171], v[64:79]
    ds_read_b64_tr_b16 v[16:17], v12 offset:24576
    ds_read_b64_tr_b16 v[18:19], v12 offset:26624
    buffer_load_dwordx4 v[208:211], v2, s[28:31], s60 offen offset:0 sc1
    v_mfma_f32_32x32x16_bf16 v[80:95], v[36:39], v[168:171], v[80:95]
    ds_read_b64_tr_b16 v[20:21], v13 offset:24576
    ds_read_b64_tr_b16 v[22:23], v13 offset:26624
    v_mfma_f32_32x32x16_bf16 v[96:111], v[40:43], v[168:171], v[96:111]
    ds_read_b64_tr_b16 v[24:25], v14 offset:24576
    ds_read_b64_tr_b16 v[26:27], v14 offset:26624
    s_mov_b32 m0, s59
    s_add_u32 s59, s59, 4096
    buffer_load_dwordx4 v9, s[40:43], s58 offen lds
    s_add_u32 s58, s58, s56
    v_mfma_f32_32x32x16_bf16 v[112:127], v[44:47], v[168:171], v[112:127]
    ds_read_b64_tr_b16 v[28:29], v15 offset:24576
    ds_read_b64_tr_b16 v[30:31], v15 offset:26624
    s_waitcnt vmcnt(19) lgkmcnt(8)
    v_mfma_f32_32x32x16_bf16 v[64:79], v[48:51], v[172:175], v[64:79]
    ds_read_b64_tr_b16 v[32:33], v12 offset:28672
    ds_read_b64_tr_b16 v[34:35], v12 offset:30720
    buffer_load_dwordx4 v[212:215], v2, s[28:31], s60 offen offset:1024 sc1
    v_mfma_f32_32x32x16_bf16 v[80:95], v[52:55], v[172:175], v[80:95]
    ds_read_b64_tr_b16 v[36:37], v13 offset:28672
    ds_read_b64_tr_b16 v[38:39], v13 offset:30720
    v_mfma_f32_32x32x16_bf16 v[96:111], v[56:59], v[172:175], v[96:111]
    ds_read_b64_tr_b16 v[40:41], v14 offset:28672
    ds_read_b64_tr_b16 v[42:43], v14 offset:30720
    s_lshl_b32 s59, s44, 10
    s_mov_b32 m0, s59
    s_add_u32 s59, s59, 4096
    buffer_load_dwordx4 v9, s[40:43], s58 offen lds
    s_add_u32 s58, s58, s56
    v_mfma_f32_32x32x16_bf16 v[112:127], v[60:63], v[172:175], v[112:127]
    ds_read_b64_tr_b16 v[44:45], v15 offset:28672
    ds_read_b64_tr_b16 v[46:47], v15 offset:30720
    s_waitcnt vmcnt(19) lgkmcnt(8)
    v_mfma_f32_32x32x16_bf16 v[64:79], v[16:19], v[176:179], v[64:79]
    ds_read_b64_tr_b16 v[48:49], v12 offset:32768
    ds_read_b64_tr_b16 v[50:51], v12 offset:34816
    buffer_load_dwordx4 v[216:219], v2, s[28:31], s60 offen offset:2048 sc1
    v_mfma_f32_32x32x16_bf16 v[80:95], v[20:23], v[176:179], v[80:95]
    ds_read_b64_tr_b16 v[52:53], v13 offset:32768
    ds_read_b64_tr_b16 v[54:55], v13 offset:34816
    v_mfma_f32_32x32x16_bf16 v[96:111], v[24:27], v[176:179], v[96:111]
    ds_read_b64_tr_b16 v[56:57], v14 offset:32768
    ds_read_b64_tr_b16 v[58:59], v14 offset:34816
    v_mfma_f32_32x32x16_bf16 v[112:127], v[28:31], v[176:179], v[112:127]
    ds_read_b64_tr_b16 v[60:61], v15 offset:32768
    ds_read_b64_tr_b16 v[62:63], v15 offset:34816
    s_waitcnt vmcnt(18) lgkmcnt(8)
    v_mfma_f32_32x32x16_bf16 v[64:79], v[32:35], v[180:183], v[64:79]
    ds_read_b64_tr_b16 v[16:17], v12 offset:36864
    ds_read_b64_tr_b16 v[18:19], v12 offset:38912
    buffer_load_dwordx4 v[220:223], v2, s[28:31], s60 offen offset:3072 sc1
    s_add_u32 s60, s60, 4096
    v_mfma_f32_32x32x16_bf16 v[80:95], v[36:39], v[180:183], v[80:95]
    ds_read_b64_tr_b16 v[20:21], v13 offset:36864
    ds_read_b64_tr_b16 v[22:23], v13 offset:38912
    v_mfma_f32_32x32x16_bf16 v[96:111], v[40:43], v[180:183], v[96:111]
    ds_read_b64_tr_b16 v[24:25], v14 offset:36864
    ds_read_b64_tr_b16 v[26:27], v14 offset:38912
    v_mfma_f32_32x32x16_bf16 v[112:127], v[44:47], v[180:183], v[112:127]
    ds_read_b64_tr_b16 v[28:29], v15 offset:36864
    ds_read_b64_tr_b16 v[30:31], v15 offset:38912
    s_waitcnt vmcnt(17) lgkmcnt(8)
    v_mfma_f32_32x32x16_bf16 v[64:79], v[48:51], v[184:187], v[64:79]
    ds_read_b64_tr_b16 v[32:33], v12 offset:40960
    ds_read_b64_tr_b16 v[34:35], v12 offset:43008
    buffer_load_dwordx4 v[224:227], v2, s[28:31], s60 offen offset:0 sc1
    v_mfma_f32_32x32x16_bf16 v[80:95], v[52:55], v[184:187], v[80:95]
    ds_read_b64_tr_b16 v[36:37], v13 offset:40960
    ds_read_b64_tr_b16 v[38:39], v13 offset:43008
    s_waitcnt vmcnt(15)
    v_mov_b32 v10, 159788
    v_mov_b32 v11, 1
    s_mov_b64 exec, 1
    ds_add_u32 v10, v11
    s_mov_b64 exec, -1
    v_mfma_f32_32x32x16_bf16 v[96:111], v[56:59], v[184:187], v[96:111]
    ds_read_b64_tr_b16 v[40:41], v14 offset:40960
    ds_read_b64_tr_b16 v[42:43], v14 offset:43008
    v_mfma_f32_32x32x16_bf16 v[112:127], v[60:63], v[184:187], v[112:127]
    ds_read_b64_tr_b16 v[44:45], v15 offset:40960
    ds_read_b64_tr_b16 v[46:47], v15 offset:43008
    s_waitcnt lgkmcnt(9)
    v_mfma_f32_32x32x16_bf16 v[64:79], v[16:19], v[188:191], v[64:79]
    ds_read_b64_tr_b16 v[48:49], v12 offset:45056
    ds_read_b64_tr_b16 v[50:51], v12 offset:47104
    buffer_load_dwordx4 v[228:231], v2, s[28:31], s60 offen offset:1024 sc1
    v_mfma_f32_32x32x16_bf16 v[80:95], v[20:23], v[188:191], v[80:95]
    ds_read_b64_tr_b16 v[52:53], v13 offset:45056
    ds_read_b64_tr_b16 v[54:55], v13 offset:47104
    v_mfma_f32_32x32x16_bf16 v[96:111], v[24:27], v[188:191], v[96:111]
    ds_read_b64_tr_b16 v[56:57], v14 offset:45056
    ds_read_b64_tr_b16 v[58:59], v14 offset:47104
    v_mfma_f32_32x32x16_bf16 v[112:127], v[28:31], v[188:191], v[112:127]
    ds_read_b64_tr_b16 v[60:61], v15 offset:45056
    ds_read_b64_tr_b16 v[62:63], v15 offset:47104
    v_mov_b32 v10, 159812
    v_mov_b32 v11, 1
    s_mov_b64 exec, 1
    ds_add_u32 v10, v11
    s_mov_b64 exec, -1
    s_waitcnt vmcnt(15) lgkmcnt(9)
    v_mfma_f32_32x32x16_bf16 v[64:79], v[32:35], v[192:195], v[64:79]
    ds_read_b64_tr_b16 v[16:17], v12 offset:49152
    ds_read_b64_tr_b16 v[18:19], v12 offset:51200
    buffer_load_dwordx4 v[232:235], v2, s[28:31], s60 offen offset:2048 sc1
    v_mfma_f32_32x32x16_bf16 v[80:95], v[36:39], v[192:195], v[80:95]
    ds_read_b64_tr_b16 v[20:21], v13 offset:49152
    ds_read_b64_tr_b16 v[22:23], v13 offset:51200
    v_mfma_f32_32x32x16_bf16 v[96:111], v[40:43], v[192:195], v[96:111]
    ds_read_b64_tr_b16 v[24:25], v14 offset:49152
    ds_read_b64_tr_b16 v[26:27], v14 offset:51200
    v_mfma_f32_32x32x16_bf16 v[112:127], v[44:47], v[192:195], v[112:127]
    ds_read_b64_tr_b16 v[28:29], v15 offset:49152
    ds_read_b64_tr_b16 v[30:31], v15 offset:51200
    s_waitcnt vmcnt(14) lgkmcnt(9)
    v_mfma_f32_32x32x16_bf16 v[64:79], v[48:51], v[196:199], v[64:79]
    ds_read_b64_tr_b16 v[32:33], v12 offset:53248
    ds_read_b64_tr_b16 v[34:35], v12 offset:55296
    buffer_load_dwordx4 v[236:239], v2, s[28:31], s60 offen offset:3072 sc1
    s_add_u32 s60, s60, 4096
    v_mov_b32 v6, 159788
    ds_read_b32 v7, v6
    v_mfma_f32_32x32x16_bf16 v[80:95], v[52:55], v[196:199], v[80:95]
    ds_read_b64_tr_b16 v[36:37], v13 offset:53248
    ds_read_b64_tr_b16 v[38:39], v13 offset:55296
    v_mfma_f32_32x32x16_bf16 v[96:111], v[56:59], v[196:199], v[96:111]
    ds_read_b64_tr_b16 v[40:41], v14 offset:53248
    ds_read_b64_tr_b16 v[42:43], v14 offset:55296
    v_mfma_f32_32x32x16_bf16 v[112:127], v[60:63], v[196:199], v[112:127]
    ds_read_b64_tr_b16 v[44:45], v15 offset:53248
    ds_read_b64_tr_b16 v[46:47], v15 offset:55296
    s_waitcnt vmcnt(13) lgkmcnt(9)
    v_mfma_f32_32x32x16_bf16 v[64:79], v[16:19], v[200:203], v[64:79]
    s_waitcnt lgkmcnt(6)
    v_cmp_gt_u32 vcc, 4, v7
    s_nop 0
    s_cbranch_vccnz pk_102_s
pk_102:
    v_add_u32 v12, 0xe000, v12
    v_add_u32 v13, 0xe000, v13
    v_add_u32 v14, 0xe000, v14
    v_add_u32 v15, 0xe000, v15
    ds_read_b64_tr_b16 v[48:49], v12 offset:0
    ds_read_b64_tr_b16 v[50:51], v12 offset:2048
    buffer_load_dwordx4 v[240:243], v2, s[28:31], s60 offen offset:0 sc1
    v_mfma_f32_32x32x16_bf16 v[80:95], v[20:23], v[200:203], v[80:95]
    ds_read_b64_tr_b16 v[52:53], v13 offset:0
    ds_read_b64_tr_b16 v[54:55], v13 offset:2048
    buffer_load_dwordx2 v[144:145], v5, s[28:31], s61 offen offset:0 sc1
    v_mfma_f32_32x32x16_bf16 v[96:111], v[24:27], v[200:203], v[96:111]
    ds_read_b64_tr_b16 v[56:57], v14 offset:0
    ds_read_b64_tr_b16 v[58:59], v14 offset:2048
    v_mfma_f32_32x32x16_bf16 v[112:127], v[28:31], v[200:203], v[112:127]
    ds_read_b64_tr_b16 v[60:61], v15 offset:0
    ds_read_b64_tr_b16 v[62:63], v15 offset:2048
    buffer_load_dwordx2 v[146:147], v5, s[28:31], s61 offen offset:512 sc1
    s_waitcnt vmcnt(14) lgkmcnt(8)
    v_mfma_f32_32x32x16_bf16 v[64:79], v[32:35], v[204:207], v[64:79]
    ds_read_b64_tr_b16 v[16:17], v12 offset:4096
    ds_read_b64_tr_b16 v[18:19], v12 offset:6144
    buffer_load_dwordx4 v[244:247], v2, s[28:31], s60 offen offset:1024 sc1
    v_mfma_f32_32x32x16_bf16 v[80:95], v[36:39], v[204:207], v[80:95]
    ds_read_b64_tr_b16 v[20:21], v13 offset:4096
    ds_read_b64_tr_b16 v[22:23], v13 offset:6144
    buffer_load_dwordx2 v[148:149], v5, s[28:31], s61 offen offset:1024 sc1
    v_mfma_f32_32x32x16_bf16 v[96:111], v[40:43], v[204:207], v[96:111]
    ds_read_b64_tr_b16 v[24:25], v14 offset:4096
    ds_read_b64_tr_b16 v[26:27], v14 offset:6144
    v_mfma_f32_32x32x16_bf16 v[112:127], v[44:47], v[204:207], v[112:127]
    ds_read_b64_tr_b16 v[28:29], v15 offset:4096
    ds_read_b64_tr_b16 v[30:31], v15 offset:6144
    buffer_load_dwordx2 v[150:151], v5, s[28:31], s61 offen offset:1536 sc1
    s_waitcnt vmcnt(15) lgkmcnt(8)
    v_mfma_f32_32x32x16_bf16 v[64:79], v[48:51], v[208:211], v[64:79]
    ds_read_b64_tr_b16 v[32:33], v12 offset:8192
    ds_read_b64_tr_b16 v[34:35], v12 offset:10240
    buffer_load_dwordx4 v[248:251], v2, s[28:31], s60 offen offset:2048 sc1
    v_mfma_f32_32x32x16_bf16 v[80:95], v[52:55], v[208:211], v[80:95]
    ds_read_b64_tr_b16 v[36:37], v13 offset:8192
    ds_read_b64_tr_b16 v[38:39], v13 offset:10240
    s_waitcnt vmcnt(13)
    v_mov_b32 v10, 159796
    v_mov_b32 v11, 1
    s_mov_b64 exec, 1
    ds_add_u32 v10, v11
    s_mov_b64 exec, -1
    buffer_load_dwordx2 v[152:153], v5, s[28:31], s61 offen offset:2048 sc1
    v_mfma_f32_32x32x16_bf16 v[96:111], v[56:59], v[208:211], v[96:111]
    ds_read_b64_tr_b16 v[40:41], v14 offset:8192
    ds_read_b64_tr_b16 v[42:43], v14 offset:10240
    v_mfma_f32_32x32x16_bf16 v[112:127], v[60:63], v[208:211], v[112:127]
    ds_read_b64_tr_b16 v[44:45], v15 offset:8192
    ds_read_b64_tr_b16 v[46:47], v15 offset:10240
    buffer_load_dwordx2 v[154:155], v5, s[28:31], s61 offen offset:2560 sc1
    v_mov_b32 v10, 159776
    v_mov_b32 v11, 1
    s_mov_b64 exec, 1
    ds_add_u32 v10, v11
    s_mov_b64 exec, -1
    s_waitcnt lgkmcnt(10)
    v_mfma_f32_32x32x16_bf16 v[64:79], v[16:19], v[212:215], v[64:79]
    ds_read_b64_tr_b16 v[48:49], v12 offset:12288
    ds_read_b64_tr_b16 v[50:51], v12 offset:14336
    buffer_load_dwordx4 v[252:255], v2, s[28:31], s60 offen offset:3072 sc1
    v_mfma_f32_32x32x16_bf16 v[80:95], v[20:23], v[212:215], v[80:95]
    ds_read_b64_tr_b16 v[52:53], v13 offset:12288
    ds_read_b64_tr_b16 v[54:55], v13 offset:14336
    buffer_load_dwordx2 v[156:157], v5, s[28:31], s61 offen offset:3072 sc1
    v_mfma_f32_32x32x16_bf16 v[96:111], v[24:27], v[212:215], v[96:111]
    ds_read_b64_tr_b16 v[56:57], v14 offset:12288
    ds_read_b64_tr_b16 v[58:59], v14 offset:14336
    v_mfma_f32_32x32x16_bf16 v[112:127], v[28:31], v[212:215], v[112:127]
    ds_read_b64_tr_b16 v[60:61], v15 offset:12288
    ds_read_b64_tr_b16 v[62:63], v15 offset:14336
    buffer_load_dwordx2 v[158:159], v5, s[28:31], s61 offen offset:3584 sc1
    s_waitcnt vmcnt(17) lgkmcnt(9)
    v_mfma_f32_32x32x16_bf16 v[64:79], v[32:35], v[216:219], v[64:79]
    ds_read_b64_tr_b16 v[16:17], v12 offset:16384
    ds_read_b64_tr_b16 v[18:19], v12 offset:18432
    v_mfma_f32_32x32x16_bf16 v[80:95], v[36:39], v[216:219], v[80:95]
    ds_read_b64_tr_b16 v[20:21], v13 offset:16384
    ds_read_b64_tr_b16 v[22:23], v13 offset:18432
    v_mfma_f32_32x32x16_bf16 v[96:111], v[40:43], v[216:219], v[96:111]
    ds_read_b64_tr_b16 v[24:25], v14 offset:16384
    ds_read_b64_tr_b16 v[26:27], v14 offset:18432
    v_mfma_f32_32x32x16_bf16 v[112:127], v[44:47], v[216:219], v[112:127]
    ds_read_b64_tr_b16 v[28:29], v15 offset:16384
    ds_read_b64_tr_b16 v[30:31], v15 offset:18432
    s_waitcnt vmcnt(16) lgkmcnt(8)
    v_mfma_f32_32x32x16_bf16 v[64:79], v[48:51], v[220:223], v[64:79]
    ds_read_b64_tr_b16 v[32:33], v12 offset:20480
    ds_read_b64_tr_b16 v[34:35], v12 offset:22528
    v_mov_b32 v6, 159796
    ds_read_b32 v7, v6
    v_mfma_f32_32x32x16_bf16 v[80:95], v[52:55], v[220:223], v[80:95]
    ds_read_b64_tr_b16 v[36:37], v13 offset:20480
    ds_read_b64_tr_b16 v[38:39], v13 offset:22528
    v_mfma_f32_32x32x16_bf16 v[96:111], v[56:59], v[220:223], v[96:111]
    ds_read_b64_tr_b16 v[40:41], v14 offset:20480
    ds_read_b64_tr_b16 v[42:43], v14 offset:22528
    v_mfma_f32_32x32x16_bf16 v[112:127], v[60:63], v[220:223], v[112:127]
    ds_read_b64_tr_b16 v[44:45], v15 offset:20480
    ds_read_b64_tr_b16 v[46:47], v15 offset:22528
    v_mov_b32 v10, 159816
    v_mov_b32 v11, 1
    s_mov_b64 exec, 1
    ds_add_u32 v10, v11
    s_mov_b64 exec, -1
    s_waitcnt vmcnt(15) lgkmcnt(10)
    v_mfma_f32_32x32x16_bf16 v[64:79], v[16:19], v[224:227], v[64:79]
    s_waitcnt lgkmcnt(7)
    v_cmp_gt_u32 vcc, 4, v7
    s_nop 0
    s_cbranch_vccnz pk_103_s
pk_103:
    ds_read_b64_tr_b16 v[48:49], v12 offset:24576
    ds_read_b64_tr_b16 v[50:51], v12 offset:26624
    v_mfma_f32_32x32x16_bf16 v[80:95], v[20:23], v[224:227], v[80:95]
    ds_read_b64_tr_b16 v[52:53], v13 offset:24576
    ds_read_b64_tr_b16 v[54:55], v13 offset:26624
    v_mfma_f32_32x32x16_bf16 v[96:111], v[24:27], v[224:227], v[96:111]
    ds_read_b64_tr_b16 v[56:57], v14 offset:24576
    ds_read_b64_tr_b16 v[58:59], v14 offset:26624
    v_mfma_f32_32x32x16_bf16 v[112:127], v[28:31], v[224:227], v[112:127]
    ds_read_b64_tr_b16 v[60:61], v15 offset:24576
    ds_read_b64_tr_b16 v[62:63], v15 offset:26624
    s_waitcnt vmcnt(14) lgkmcnt(9)
    v_mfma_f32_32x32x16_bf16 v[64:79], v[32:35], v[228:231], v[64:79]
    ds_read_b64_tr_b16 v[16:17], v12 offset:28672
    ds_read_b64_tr_b16 v[18:19], v12 offset:30720
    v_mfma_f32_32x32x16_bf16 v[80:95], v[36:39], v[228:231], v[80:95]
    ds_read_b64_tr_b16 v[20:21], v13 offset:28672
    ds_read_b64_tr_b16 v[22:23], v13 offset:30720
    v_mfma_f32_32x32x16_bf16 v[96:111], v[40:43], v[228:231], v[96:111]
    ds_read_b64_tr_b16 v[24:25], v14 offset:28672
    ds_read_b64_tr_b16 v[26:27], v14 offset:30720
    v_mfma_f32_32x32x16_bf16 v[112:127], v[44:47], v[228:231], v[112:127]
    ds_read_b64_tr_b16 v[28:29], v15 offset:28672
    ds_read_b64_tr_b16 v[30:31], v15 offset:30720
    s_waitcnt vmcnt(13) lgkmcnt(8)
    v_mfma_f32_32x32x16_bf16 v[64:79], v[48:51], v[232:235], v[64:79]
    ds_read_b64_tr_b16 v[32:33], v12 offset:32768
    ds_read_b64_tr_b16 v[34:35], v12 offset:34816
    v_mfma_f32_32x32x16_bf16 v[80:95], v[52:55], v[232:235], v[80:95]
    ds_read_b64_tr_b16 v[36:37], v13 offset:32768
    ds_read_b64_tr_b16 v[38:39], v13 offset:34816
    v_mfma_f32_32x32x16_bf16 v[96:111], v[56:59], v[232:235], v[96:111]
    ds_read_b64_tr_b16 v[40:41], v14 offset:32768
    ds_read_b64_tr_b16 v[42:43], v14 offset:34816
    v_mfma_f32_32x32x16_bf16 v[112:127], v[60:63], v[232:235], v[112:127]
    ds_read_b64_tr_b16 v[44:45], v15 offset:32768
    ds_read_b64_tr_b16 v[46:47], v15 offset:34816
    s_waitcnt vmcnt(12) lgkmcnt(8)
    v_mfma_f32_32x32x16_bf16 v[64:79], v[16:19], v[236:239], v[64:79]
    ds_read_b64_tr_b16 v[48:49], v12 offset:36864
    ds_read_b64_tr_b16 v[50:51], v12 offset:38912
    v_mfma_f32_32x32x16_bf16 v[80:95], v[20:23], v[236:239], v[80:95]
    ds_read_b64_tr_b16 v[52:53], v13 offset:36864
    ds_read_b64_tr_b16 v[54:55], v13 offset:38912
    s_mov_b32 exec_hi, 0
    buffer_load_dwordx4 v[128:131], v2, s[28:31], s62 offen offset:0 sc1
    buffer_load_dwordx4 v[132:135], v2, s[28:31], s62 offen offset:512 sc1
    buffer_load_dwordx4 v[136:139], v2, s[28:31], s62 offen offset:1024 sc1
    buffer_load_dwordx4 v[140:143], v2, s[28:31], s62 offen offset:1536 sc1
    s_mov_b64 exec, -1
    v_mfma_f32_32x32x16_bf16 v[96:111], v[24:27], v[236:239], v[96:111]
    ds_read_b64_tr_b16 v[56:57], v14 offset:36864
    ds_read_b64_tr_b16 v[58:59], v14 offset:38912
    v_mfma_f32_32x32x16_bf16 v[112:127], v[28:31], v[236:239], v[112:127]
    ds_read_b64_tr_b16 v[60:61], v15 offset:36864
    ds_read_b64_tr_b16 v[62:63], v15 offset:38912
    s_waitcnt vmcnt(15) lgkmcnt(8)
    v_mfma_f32_32x32x16_bf16 v[64:79], v[32:35], v[240:243], v[64:79]
    ds_read_b64_tr_b16 v[16:17], v12 offset:40960
    ds_read_b64_tr_b16 v[18:19], v12 offset:43008
    v_mfma_f32_32x32x16_bf16 v[80:95], v[36:39], v[240:243], v[80:95]
    ds_read_b64_tr_b16 v[20:21], v13 offset:40960
    ds_read_b64_tr_b16 v[22:23], v13 offset:43008
    v_mfma_f32_32x32x16_bf16 v[96:111], v[40:43], v[240:243], v[96:111]
    ds_read_b64_tr_b16 v[24:25], v14 offset:40960
    ds_read_b64_tr_b16 v[26:27], v14 offset:43008
    v_mfma_f32_32x32x16_bf16 v[112:127], v[44:47], v[240:243], v[112:127]
    ds_read_b64_tr_b16 v[28:29], v15 offset:40960
    ds_read_b64_tr_b16 v[30:31], v15 offset:43008
    s_waitcnt vmcnt(12) lgkmcnt(8)
    v_mfma_f32_32x32x16_bf16 v[64:79], v[48:51], v[244:247], v[64:79]
    v_add_u32 v12, 0xfffe4000, v12
    v_add_u32 v13, 0xfffe4000, v13
    v_add_u32 v14, 0xfffe4000, v14
    v_add_u32 v15, 0xfffe4000, v15
    ds_read_b64_tr_b16 v[32:33], v12 offset:0
    ds_read_b64_tr_b16 v[34:35], v12 offset:2048
    s_waitcnt vmcnt(4)
    v_add_f32 v144, v144, v146
    v_add_f32 v145, v145, v147
    v_add_f32 v144, v144, v148
    v_mfma_f32_32x32x16_bf16 v[80:95], v[52:55], v[244:247], v[80:95]
    ds_read_b64_tr_b16 v[36:37], v13 offset:0
    ds_read_b64_tr_b16 v[38:39], v13 offset:2048
    v_add_f32 v145, v145, v149
    v_add_f32 v144, v144, v150
    v_add_f32 v145, v145, v151
    v_add_f32 v144, v144, v152
    v_mfma_f32_32x32x16_bf16 v[96:111], v[56:59], v[244:247], v[96:111]
    ds_read_b64_tr_b16 v[40:41], v14 offset:0
    ds_read_b64_tr_b16 v[42:43], v14 offset:2048
    v_add_f32 v145, v145, v153
    v_add_f32 v144, v144, v154
    v_add_f32 v145, v145, v155
    v_add_f32 v144, v144, v156
    v_mfma_f32_32x32x16_bf16 v[112:127], v[60:63], v[244:247], v[112:127]
    ds_read_b64_tr_b16 v[44:45], v15 offset:0
    ds_read_b64_tr_b16 v[46:47], v15 offset:2048
    v_add_f32 v145, v145, v157
    v_add_f32 v144, v144, v158
    v_add_f32 v145, v145, v159
    v_mov_b32 v146, v144
    s_waitcnt lgkmcnt(8)
    v_mfma_f32_32x32x16_bf16 v[64:79], v[16:19], v[248:251], v[64:79]
    v_permlane32_swap_b32 v144, v146
    v_add_f32 v144, v144, v146
    v_mov_b32 v147, v145
    s_nop 1
    v_permlane32_swap_b32 v145, v147
    v_mfma_f32_32x32x16_bf16 v[80:95], v[20:23], v[248:251], v[80:95]
    v_add_f32 v145, v145, v147
    v_mul_f32 v144, 0x3b000000, v144
    v_mul_f32 v145, 0x3b000000, v145
    v_fma_f32 v145, -v144, v144, v145
    v_mfma_f32_32x32x16_bf16 v[96:111], v[24:27], v[248:251], v[96:111]
    v_max_f32 v145, 0, v145
    v_add_f32 v145, 0x3727c5ac, v145
    v_rsq_f32 v148, v145
    s_nop 0
    v_mul_f32 v164, 0xc0135761, v148
    v_mfma_f32_32x32x16_bf16 v[112:127], v[28:31], v[248:251], v[112:127]
    v_mul_f32 v166, v148, v148
    v_mul_f32 v168, v145, v148
    v_mul_f32 v166, v166, v164
    v_mov_b32 v165, v164
    s_waitcnt lgkmcnt(0)
    v_mfma_f32_32x32x16_bf16 v[64:79], v[32:35], v[252:255], v[64:79]
    v_mul_f32 v166, 0x3d372713, v166
    v_mov_b32 v169, v168
    v_mov_b32 v167, v166
    v_sub_f32 v144, 0, v144
    v_mfma_f32_32x32x16_bf16 v[80:95], v[36:39], v[252:255], v[80:95]
    v_cvt_pk_bf16_f32 v160, v144, v144
    v_and_b32 v146, 0xffff0000, v160
    v_sub_f32 v146, v144, v146
    v_cvt_pk_bf16_f32 v161, v146, 0
    v_mfma_f32_32x32x16_bf16 v[96:111], v[40:43], v[252:255], v[96:111]
    v_mov_b32 v162, 0
    v_mov_b32 v163, 0
    v_mfma_f32_32x32x16_bf16 v[112:127], v[44:47], v[252:255], v[112:127]
    v_mov_b32 v10, 159820
    v_mov_b32 v11, 1
    s_mov_b64 exec, 1
    ds_add_u32 v10, v11
    s_mov_b64 exec, -1
    s_waitcnt vmcnt(0)
    s_mov_b32 s10, 0x40000
csl_104:
    s_mov_b32 exec_hi, 0
    v_cmp_ne_u32 vcc, s3, v131
    v_cmp_ne_u32 s[64:65], s3, v135
    s_nop 0
    s_or_b64 vcc, vcc, s[64:65]
    v_cmp_ne_u32 s[64:65], s3, v139
    s_nop 0
    s_or_b64 vcc, vcc, s[64:65]
    v_cmp_ne_u32 s[64:65], s3, v143
    s_nop 0
    s_or_b64 vcc, vcc, s[64:65]
    s_mov_b64 exec, -1
    s_cbranch_vccz csok_105
    s_sleep 4
    s_mov_b32 exec_hi, 0
    buffer_load_dwordx4 v[128:131], v2, s[28:31], s62 offen offset:0 sc1
    buffer_load_dwordx4 v[132:135], v2, s[28:31], s62 offen offset:512 sc1
    buffer_load_dwordx4 v[136:139], v2, s[28:31], s62 offen offset:1024 sc1
    buffer_load_dwordx4 v[140:143], v2, s[28:31], s62 offen offset:1536 sc1
    s_mov_b64 exec, -1
    s_waitcnt vmcnt(0)
    s_sub_u32 s10, s10, 1
    s_cbranch_scc0 csl_104
csok_105:
    v_mov_b32 v131, 0
    v_mov_b32 v135, 0
    v_mov_b32 v139, 0
    v_mov_b32 v143, 0
    v_mfma_f32_32x32x16_bf16 v[64:79], v[128:131], v[160:163], v[64:79]
    v_mfma_f32_32x32x16_bf16 v[80:95], v[132:135], v[160:163], v[80:95]
    v_mfma_f32_32x32x16_bf16 v[96:111], v[136:139], v[160:163], v[96:111]
    v_mfma_f32_32x32x16_bf16 v[112:127], v[140:143], v[160:163], v[112:127]
    s_nop 8
    v_pk_mul_f32 v[176:177], v[64:65], v[64:65]
    v_pk_mul_f32 v[178:179], v[66:67], v[66:67]
    v_pk_mul_f32 v[180:181], v[68:69], v[68:69]
    v_pk_mul_f32 v[182:183], v[70:71], v[70:71]
    v_pk_mul_f32 v[184:185], v[72:73], v[72:73]
    v_pk_mul_f32 v[186:187], v[74:75], v[74:75]
    v_pk_mul_f32 v[188:189], v[76:77], v[76:77]
    v_pk_mul_f32 v[190:191], v[78:79], v[78:79]
    v_pk_fma_f32 v[176:177], v[176:177], v[166:167], v[164:165]
    v_pk_fma_f32 v[178:179], v[178:179], v[166:167], v[164:165]
    v_pk_fma_f32 v[180:181], v[180:181], v[166:167], v[164:165]
    v_pk_fma_f32 v[182:183], v[182:183], v[166:167], v[164:165]
    v_pk_fma_f32 v[184:185], v[184:185], v[166:167], v[164:165]
    v_pk_fma_f32 v[186:187], v[186:187], v[166:167], v[164:165]
    v_pk_fma_f32 v[188:189], v[188:189], v[166:167], v[164:165]
    v_pk_fma_f32 v[190:191], v[190:191], v[166:167], v[164:165]
    v_pk_mul_f32 v[176:177], v[176:177], v[64:65]
    v_pk_mul_f32 v[178:179], v[178:179], v[66:67]
    v_pk_mul_f32 v[180:181], v[180:181], v[68:69]
    v_pk_mul_f32 v[182:183], v[182:183], v[70:71]
    v_pk_mul_f32 v[184:185], v[184:185], v[72:73]
    v_pk_mul_f32 v[186:187], v[186:187], v[74:75]
    v_pk_mul_f32 v[188:189], v[188:189], v[76:77]
    v_pk_mul_f32 v[190:191], v[190:191], v[78:79]
    v_exp_f32 v176, v176
    v_exp_f32 v177, v177
    v_exp_f32 v178, v178
    v_exp_f32 v179, v179
    v_exp_f32 v180, v180
    v_exp_f32 v181, v181
    v_exp_f32 v182, v182
    v_exp_f32 v183, v183
    v_exp_f32 v184, v184
    v_exp_f32 v185, v185
    v_exp_f32 v186, v186
    v_exp_f32 v187, v187
    v_exp_f32 v188, v188
    v_exp_f32 v189, v189
    v_exp_f32 v190, v190
    v_exp_f32 v191, v191
    v_pk_fma_f32 v[176:177], v[176:177], v[168:169], v[168:169]
    v_pk_fma_f32 v[178:179], v[178:179], v[168:169], v[168:169]
    v_pk_fma_f32 v[180:181], v[180:181], v[168:169], v[168:169]
    v_pk_fma_f32 v[182:183], v[182:183], v[168:169], v[168:169]
    v_pk_fma_f32 v[184:185], v[184:185], v[168:169], v[168:169]
    v_pk_fma_f32 v[186:187], v[186:187], v[168:169], v[168:169]
    v_pk_fma_f32 v[188:189], v[188:189], v[168:169], v[168:169]
    v_pk_fma_f32 v[190:191], v[190:191], v[168:169], v[168:169]
    v_rcp_f32 v176, v176
    v_rcp_f32 v177, v177
    v_rcp_f32 v178, v178
    v_rcp_f32 v179, v179
    v_rcp_f32 v180, v180
    v_rcp_f32 v181, v181
    v_rcp_f32 v182, v182
    v_rcp_f32 v183, v183
    v_rcp_f32 v184, v184
    v_rcp_f32 v185, v185
    v_rcp_f32 v186, v186
    v_rcp_f32 v187, v187
    v_rcp_f32 v188, v188
    v_rcp_f32 v189, v189
    v_rcp_f32 v190, v190
    v_rcp_f32 v191, v191
    v_pk_mul_f32 v[176:177], v[176:177], v[64:65]
    v_pk_mul_f32 v[178:179], v[178:179], v[66:67]
    v_pk_mul_f32 v[180:181], v[180:181], v[68:69]
    v_pk_mul_f32 v[182:183], v[182:183], v[70:71]
    v_pk_mul_f32 v[184:185], v[184:185], v[72:73]
    v_pk_mul_f32 v[186:187], v[186:187], v[74:75]
    v_pk_mul_f32 v[188:189], v[188:189], v[76:77]
    v_pk_mul_f32 v[190:191], v[190:191], v[78:79]
    v_cvt_pk_bf16_f32 v192, v176, v177
    v_cvt_pk_bf16_f32 v193, v178, v179
    v_cvt_pk_bf16_f32 v194, v180, v181
    v_cvt_pk_bf16_f32 v195, v182, v183
    v_cvt_pk_bf16_f32 v196, v184, v185
    v_cvt_pk_bf16_f32 v197, v186, v187
    v_cvt_pk_bf16_f32 v198, v188, v189
    v_cvt_pk_bf16_f32 v199, v190, v191
    buffer_store_dwordx4 v[192:195], v2, s[28:31], s68 offen sc1
    buffer_store_dwordx4 v[196:199], v2, s[28:31], s68 offen offset:1024 sc1
    v_pk_mul_f32 v[176:177], v[80:81], v[80:81]
    v_pk_mul_f32 v[178:179], v[82:83], v[82:83]
    v_pk_mul_f32 v[180:181], v[84:85], v[84:85]
    v_pk_mul_f32 v[182:183], v[86:87], v[86:87]
    v_pk_mul_f32 v[184:185], v[88:89], v[88:89]
    v_pk_mul_f32 v[186:187], v[90:91], v[90:91]
    v_pk_mul_f32 v[188:189], v[92:93], v[92:93]
    v_pk_mul_f32 v[190:191], v[94:95], v[94:95]
    v_pk_fma_f32 v[176:177], v[176:177], v[166:167], v[164:165]
    v_pk_fma_f32 v[178:179], v[178:179], v[166:167], v[164:165]
    v_pk_fma_f32 v[180:181], v[180:181], v[166:167], v[164:165]
    v_pk_fma_f32 v[182:183], v[182:183], v[166:167], v[164:165]
    v_pk_fma_f32 v[184:185], v[184:185], v[166:167], v[164:165]
    v_pk_fma_f32 v[186:187], v[186:187], v[166:167], v[164:165]
    v_pk_fma_f32 v[188:189], v[188:189], v[166:167], v[164:165]
    v_pk_fma_f32 v[190:191], v[190:191], v[166:167], v[164:165]
    v_pk_mul_f32 v[176:177], v[176:177], v[80:81]
    v_pk_mul_f32 v[178:179], v[178:179], v[82:83]
    v_pk_mul_f32 v[180:181], v[180:181], v[84:85]
    v_pk_mul_f32 v[182:183], v[182:183], v[86:87]
    v_pk_mul_f32 v[184:185], v[184:185], v[88:89]
    v_pk_mul_f32 v[186:187], v[186:187], v[90:91]
    v_pk_mul_f32 v[188:189], v[188:189], v[92:93]
    v_pk_mul_f32 v[190:191], v[190:191], v[94:95]
    v_exp_f32 v176, v176
    v_exp_f32 v177, v177
    v_exp_f32 v178, v178
    v_exp_f32 v179, v179
    v_exp_f32 v180, v180
    v_exp_f32 v181, v181
    v_exp_f32 v182, v182
    v_exp_f32 v183, v183
    v_exp_f32 v184, v184
    v_exp_f32 v185, v185
    v_exp_f32 v186, v186
    v_exp_f32 v187, v187
    v_exp_f32 v188, v188
    v_exp_f32 v189, v189
    v_exp_f32 v190, v190
    v_exp_f32 v191, v191
    v_pk_fma_f32 v[176:177], v[176:177], v[168:169], v[168:169]
    v_pk_fma_f32 v[178:179], v[178:179], v[168:169], v[168:169]
    v_pk_fma_f32 v[180:181], v[180:181], v[168:169], v[168:169]
    v_pk_fma_f32 v[182:183], v[182:183], v[168:169], v[168:169]
    v_pk_fma_f32 v[184:185], v[184:185], v[168:169], v[168:169]
    v_pk_fma_f32 v[186:187], v[186:187], v[168:169], v[168:169]
    v_pk_fma_f32 v[188:189], v[188:189], v[168:169], v[168:169]
    v_pk_fma_f32 v[190:191], v[190:191], v[168:169], v[168:169]
    v_rcp_f32 v176, v176
    v_rcp_f32 v177, v177
    v_rcp_f32 v178, v178
    v_rcp_f32 v179, v179
    v_rcp_f32 v180, v180
    v_rcp_f32 v181, v181
    v_rcp_f32 v182, v182
    v_rcp_f32 v183, v183
    v_rcp_f32 v184, v184
    v_rcp_f32 v185, v185
    v_rcp_f32 v186, v186
    v_rcp_f32 v187, v187
    v_rcp_f32 v188, v188
    v_rcp_f32 v189, v189
    v_rcp_f32 v190, v190
    v_rcp_f32 v191, v191
    v_pk_mul_f32 v[176:177], v[176:177], v[80:81]
    v_pk_mul_f32 v[178:179], v[178:179], v[82:83]
    v_pk_mul_f32 v[180:181], v[180:181], v[84:85]
    v_pk_mul_f32 v[182:183], v[182:183], v[86:87]
    v_pk_mul_f32 v[184:185], v[184:185], v[88:89]
    v_pk_mul_f32 v[186:187], v[186:187], v[90:91]
    v_pk_mul_f32 v[188:189], v[188:189], v[92:93]
    v_pk_mul_f32 v[190:191], v[190:191], v[94:95]
    v_cvt_pk_bf16_f32 v200, v176, v177
    v_cvt_pk_bf16_f32 v201, v178, v179
    v_cvt_pk_bf16_f32 v202, v180, v181
    v_cvt_pk_bf16_f32 v203, v182, v183
    v_cvt_pk_bf16_f32 v204, v184, v185
    v_cvt_pk_bf16_f32 v205, v186, v187
    v_cvt_pk_bf16_f32 v206, v188, v189
    v_cvt_pk_bf16_f32 v207, v190, v191
    buffer_store_dwordx4 v[200:203], v2, s[28:31], s68 offen offset:2048 sc1
    buffer_store_dwordx4 v[204:207], v2, s[28:31], s68 offen offset:3072 sc1
    v_pk_mul_f32 v[176:177], v[96:97], v[96:97]
    v_pk_mul_f32 v[178:179], v[98:99], v[98:99]
    v_pk_mul_f32 v[180:181], v[100:101], v[100:101]
    v_pk_mul_f32 v[182:183], v[102:103], v[102:103]
    v_pk_mul_f32 v[184:185], v[104:105], v[104:105]
    v_pk_mul_f32 v[186:187], v[106:107], v[106:107]
    v_pk_mul_f32 v[188:189], v[108:109], v[108:109]
    v_pk_mul_f32 v[190:191], v[110:111], v[110:111]
    v_pk_fma_f32 v[176:177], v[176:177], v[166:167], v[164:165]
    v_pk_fma_f32 v[178:179], v[178:179], v[166:167], v[164:165]
    v_pk_fma_f32 v[180:181], v[180:181], v[166:167], v[164:165]
    v_pk_fma_f32 v[182:183], v[182:183], v[166:167], v[164:165]
    v_pk_fma_f32 v[184:185], v[184:185], v[166:167], v[164:165]
    v_pk_fma_f32 v[186:187], v[186:187], v[166:167], v[164:165]
    v_pk_fma_f32 v[188:189], v[188:189], v[166:167], v[164:165]
    v_pk_fma_f32 v[190:191], v[190:191], v[166:167], v[164:165]
    v_pk_mul_f32 v[176:177], v[176:177], v[96:97]
    v_pk_mul_f32 v[178:179], v[178:179], v[98:99]
    v_pk_mul_f32 v[180:181], v[180:181], v[100:101]
    v_pk_mul_f32 v[182:183], v[182:183], v[102:103]
    v_pk_mul_f32 v[184:185], v[184:185], v[104:105]
    v_pk_mul_f32 v[186:187], v[186:187], v[106:107]
    v_pk_mul_f32 v[188:189], v[188:189], v[108:109]
    v_pk_mul_f32 v[190:191], v[190:191], v[110:111]
    v_exp_f32 v176, v176
    v_exp_f32 v177, v177
    v_exp_f32 v178, v178
    v_exp_f32 v179, v179
    v_exp_f32 v180, v180
    v_exp_f32 v181, v181
    v_exp_f32 v182, v182
    v_exp_f32 v183, v183
    v_exp_f32 v184, v184
    v_exp_f32 v185, v185
    v_exp_f32 v186, v186
    v_exp_f32 v187, v187
    v_exp_f32 v188, v188
    v_exp_f32 v189, v189
    v_exp_f32 v190, v190
    v_exp_f32 v191, v191
    v_pk_fma_f32 v[176:177], v[176:177], v[168:169], v[168:169]
    v_pk_fma_f32 v[178:179], v[178:179], v[168:169], v[168:169]
    v_pk_fma_f32 v[180:181], v[180:181], v[168:169], v[168:169]
    v_pk_fma_f32 v[182:183], v[182:183], v[168:169], v[168:169]
    v_pk_fma_f32 v[184:185], v[184:185], v[168:169], v[168:169]
    v_pk_fma_f32 v[186:187], v[186:187], v[168:169], v[168:169]
    v_pk_fma_f32 v[188:189], v[188:189], v[168:169], v[168:169]
    v_pk_fma_f32 v[190:191], v[190:191], v[168:169], v[168:169]
    v_rcp_f32 v176, v176
    v_rcp_f32 v177, v177
    v_rcp_f32 v178, v178
    v_rcp_f32 v179, v179
    v_rcp_f32 v180, v180
    v_rcp_f32 v181, v181
    v_rcp_f32 v182, v182
    v_rcp_f32 v183, v183
    v_rcp_f32 v184, v184
    v_rcp_f32 v185, v185
    v_rcp_f32 v186, v186
    v_rcp_f32 v187, v187
    v_rcp_f32 v188, v188
    v_rcp_f32 v189, v189
    v_rcp_f32 v190, v190
    v_rcp_f32 v191, v191
    v_pk_mul_f32 v[176:177], v[176:177], v[96:97]
    v_pk_mul_f32 v[178:179], v[178:179], v[98:99]
    v_pk_mul_f32 v[180:181], v[180:181], v[100:101]
    v_pk_mul_f32 v[182:183], v[182:183], v[102:103]
    v_pk_mul_f32 v[184:185], v[184:185], v[104:105]
    v_pk_mul_f32 v[186:187], v[186:187], v[106:107]
    v_pk_mul_f32 v[188:189], v[188:189], v[108:109]
    v_pk_mul_f32 v[190:191], v[190:191], v[110:111]
    v_cvt_pk_bf16_f32 v208, v176, v177
    v_cvt_pk_bf16_f32 v209, v178, v179
    v_cvt_pk_bf16_f32 v210, v180, v181
    v_cvt_pk_bf16_f32 v211, v182, v183
    v_cvt_pk_bf16_f32 v212, v184, v185
    v_cvt_pk_bf16_f32 v213, v186, v187
    v_cvt_pk_bf16_f32 v214, v188, v189
    v_cvt_pk_bf16_f32 v215, v190, v191
    buffer_store_dwordx4 v[208:211], v2, s[28:31], s69 offen sc1
    buffer_store_dwordx4 v[212:215], v2, s[28:31], s69 offen offset:1024 sc1
    s_cmp_eq_u32 s96, 10
    s_cbranch_scc1 P3done_92
    v_pk_mul_f32 v[176:177], v[112:113], v[112:113]
    v_pk_mul_f32 v[178:179], v[114:115], v[114:115]
    v_pk_mul_f32 v[180:181], v[116:117], v[116:117]
    v_pk_mul_f32 v[182:183], v[118:119], v[118:119]
    v_pk_mul_f32 v[184:185], v[120:121], v[120:121]
    v_pk_mul_f32 v[186:187], v[122:123], v[122:123]
    v_pk_mul_f32 v[188:189], v[124:125], v[124:125]
    v_pk_mul_f32 v[190:191], v[126:127], v[126:127]
    v_pk_fma_f32 v[176:177], v[176:177], v[166:167], v[164:165]
    v_pk_fma_f32 v[178:179], v[178:179], v[166:167], v[164:165]
    v_pk_fma_f32 v[180:181], v[180:181], v[166:167], v[164:165]
    v_pk_fma_f32 v[182:183], v[182:183], v[166:167], v[164:165]
    v_pk_fma_f32 v[184:185], v[184:185], v[166:167], v[164:165]
    v_pk_fma_f32 v[186:187], v[186:187], v[166:167], v[164:165]
    v_pk_fma_f32 v[188:189], v[188:189], v[166:167], v[164:165]
    v_pk_fma_f32 v[190:191], v[190:191], v[166:167], v[164:165]
    v_pk_mul_f32 v[176:177], v[176:177], v[112:113]
    v_pk_mul_f32 v[178:179], v[178:179], v[114:115]
    v_pk_mul_f32 v[180:181], v[180:181], v[116:117]
    v_pk_mul_f32 v[182:183], v[182:183], v[118:119]
    v_pk_mul_f32 v[184:185], v[184:185], v[120:121]
    v_pk_mul_f32 v[186:187], v[186:187], v[122:123]
    v_pk_mul_f32 v[188:189], v[188:189], v[124:125]
    v_pk_mul_f32 v[190:191], v[190:191], v[126:127]
    v_exp_f32 v176, v176
    v_exp_f32 v177, v177
    v_exp_f32 v178, v178
    v_exp_f32 v179, v179
    v_exp_f32 v180, v180
    v_exp_f32 v181, v181
    v_exp_f32 v182, v182
    v_exp_f32 v183, v183
    v_exp_f32 v184, v184
    v_exp_f32 v185, v185
    v_exp_f32 v186, v186
    v_exp_f32 v187, v187
    v_exp_f32 v188, v188
    v_exp_f32 v189, v189
    v_exp_f32 v190, v190
    v_exp_f32 v191, v191
    v_pk_fma_f32 v[176:177], v[176:177], v[168:169], v[168:169]
    v_pk_fma_f32 v[178:179], v[178:179], v[168:169], v[168:169]
    v_pk_fma_f32 v[180:181], v[180:181], v[168:169], v[168:169]
    v_pk_fma_f32 v[182:183], v[182:183], v[168:169], v[168:169]
    v_pk_fma_f32 v[184:185], v[184:185], v[168:169], v[168:169]
    v_pk_fma_f32 v[186:187], v[186:187], v[168:169], v[168:169]
    v_pk_fma_f32 v[188:189], v[188:189], v[168:169], v[168:169]
    v_pk_fma_f32 v[190:191], v[190:191], v[168:169], v[168:169]
    v_rcp_f32 v176, v176
    v_rcp_f32 v177, v177
    v_rcp_f32 v178, v178
    v_rcp_f32 v179, v179
    v_rcp_f32 v180, v180
    v_rcp_f32 v181, v181
    v_rcp_f32 v182, v182
    v_rcp_f32 v183, v183
    v_rcp_f32 v184, v184
    v_rcp_f32 v185, v185
    v_rcp_f32 v186, v186
    v_rcp_f32 v187, v187
    v_rcp_f32 v188, v188
    v_rcp_f32 v189, v189
    v_rcp_f32 v190, v190
    v_rcp_f32 v191, v191
    v_pk_mul_f32 v[176:177], v[176:177], v[112:113]
    v_pk_mul_f32 v[178:179], v[178:179], v[114:115]
    v_pk_mul_f32 v[180:181], v[180:181], v[116:117]
    v_pk_mul_f32 v[182:183], v[182:183], v[118:119]
    v_pk_mul_f32 v[184:185], v[184:185], v[120:121]
    v_pk_mul_f32 v[186:187], v[186:187], v[122:123]
    v_pk_mul_f32 v[188:189], v[188:189], v[124:125]
    v_pk_mul_f32 v[190:191], v[190:191], v[126:127]
    v_cvt_pk_bf16_f32 v216, v176, v177
    v_cvt_pk_bf16_f32 v217, v178, v179
    v_cvt_pk_bf16_f32 v218, v180, v181
    v_cvt_pk_bf16_f32 v219, v182, v183
    v_cvt_pk_bf16_f32 v220, v184, v185
    v_cvt_pk_bf16_f32 v221, v186, v187
    v_cvt_pk_bf16_f32 v222, v188, v189
    v_cvt_pk_bf16_f32 v223, v190, v191
    buffer_store_dwordx4 v[216:219], v2, s[28:31], s69 offen offset:2048 sc1
    buffer_store_dwordx4 v[220:223], v2, s[28:31], s69 offen offset:3072 sc1
    s_branch P3done_92
P3wo_91:
    s_setprio 0
    s_cmp_eq_u32 s96, 15
    s_cbranch_scc1 P3idle_90
    s_mov_b32 s10, 0x200000
aw_106:
    v_mov_b32 v10, 159744
    ds_read_b64 v[10:11], v10
    s_waitcnt lgkmcnt(0)
    v_cmp_gt_u32 vcc, 8, v10
    v_cmp_gt_u32 s[54:55], 4, v11
    s_nop 0
    s_or_b64 vcc, vcc, s[54:55]
    s_cbranch_vccz aw_done_107
    s_sleep 1
    s_sub_u32 s10, s10, 1
    s_cbranch_scc0 aw_106
aw_done_107:
    s_mov_b32 m0, s59
    s_add_u32 s59, s59, 4096
    buffer_load_dwordx4 v9, s[40:43], s58 offen lds
    s_add_u32 s58, s58, s56
    s_mov_b32 m0, s59
    s_add_u32 s59, s59, 4096
    buffer_load_dwordx4 v9, s[40:43], s58 offen lds
    s_add_u32 s58, s58, s56
    s_mov_b32 m0, s59
    s_add_u32 s59, s59, 4096
    buffer_load_dwordx4 v9, s[40:43], s58 offen lds
    s_add_u32 s58, s58, s56
    s_mov_b32 m0, s59
    s_add_u32 s59, s59, 4096
    buffer_load_dwordx4 v9, s[40:43], s58 offen lds
    s_add_u32 s58, s58, s56
    v_bfe_u32 v5, v1, 2, 2
    v_lshlrev_b32 v12, 2, v4
    v_add_u32 v12, v12, v5
    v_lshlrev_b32 v12, 7, v12
    v_lshrrev_b32 v5, 1, v5
    v_lshl_add_u32 v12, v5, 6, v12
    v_bfe_u32 v5, v1, 4, 1
    v_lshl_add_u32 v12, v5, 5, v12
    v_and_b32 v5, 3, v1
    v_lshl_add_u32 v12, v5, 3, v12
    v_add_u32 v12, 94208, v12
    v_xor_b32 v13, 64, v12
    v_lshlrev_b32 v7, 2, v3
    v_add_u32 v8, 65536, v7
    s_lshl_b32 s98, s50, 3
    s_add_u32 s98, s98, s44
    s_and_b32 s62, s97, 1
    s_lshl_b32 s62, s62, 2
    s_add_u32 s62, s62, s96
    s_mov_b64 s[32:33], s[18:19]
    s_mov_b32 s34, 1409024
    s_mov_b32 s35, 0x20000
    s_lshl_b32 s53, s48, 7
    s_lshl_b32 s52, s44, 13
    s_add_u32 s53, s53, s52
    s_lshl_b32 s54, s44, 10
    s_add_u32 m0, s54, 32768
    s_add_u32 s52, s53, 425984
    buffer_load_dwordx4 v6, s[32:35], s52 offen lds
    s_add_u32 m0, s54, 36864
    s_add_u32 s52, s53, 524288
    buffer_load_dwordx4 v6, s[32:35], s52 offen lds
    s_add_u32 m0, s54, 40960
    s_add_u32 s52, s53, 557056
    buffer_load_dwordx4 v6, s[32:35], s52 offen lds
    s_add_u32 m0, s54, 45056
    s_add_u32 s52, s53, 655360
    buffer_load_dwordx4 v6, s[32:35], s52 offen lds
    s_add_u32 m0, s54, 49152
    s_add_u32 s52, s53, 688128
    buffer_load_dwordx4 v6, s[32:35], s52 offen lds
    s_add_u32 m0, s54, 53248
    s_add_u32 s52, s53, 786432
    buffer_load_dwordx4 v6, s[32:35], s52 offen lds
    s_add_u32 m0, s54, 57344
    s_add_u32 s52, s53, 819200
    buffer_load_dwordx4 v6, s[32:35], s52 offen lds
    s_add_u32 m0, s54, 61440
    s_add_u32 s52, s53, 917504
    buffer_load_dwordx4 v6, s[32:35], s52 offen lds
    s_add_u32 m0, s54, 65536
    s_add_u32 s52, s53, 950272
    buffer_load_dwordx4 v6, s[32:35], s52 offen lds
    s_add_u32 m0, s54, 69632
    s_add_u32 s52, s53, 1048576
    buffer_load_dwordx4 v6, s[32:35], s52 offen lds
    s_add_u32 m0, s54, 73728
    s_add_u32 s52, s53, 1081344
    buffer_load_dwordx4 v6, s[32:35], s52 offen lds
    s_add_u32 m0, s54, 77824
    s_add_u32 s52, s53, 1179648
    buffer_load_dwordx4 v6, s[32:35], s52 offen lds
    s_add_u32 m0, s54, 81920
    s_add_u32 s52, s53, 1212416
    buffer_load_dwordx4 v6, s[32:35], s52 offen lds
    s_add_u32 m0, s54, 86016
    s_add_u32 s52, s53, 1310720
    buffer_load_dwordx4 v6, s[32:35], s52 offen lds
    s_add_u32 m0, s54, 90112
    s_add_u32 s52, s53, 1343488
    buffer_load_dwordx4 v6, s[32:35], s52 offen lds
    s_waitcnt vmcnt(0)
    v_mov_b32 v10, 159752
    v_mov_b32 v11, 1
    s_mov_b64 exec, 1
    ds_add_u32 v10, v11
    s_mov_b64 exec, -1
    v_mov_b32 v10, 159808
    v_mov_b32 v11, 1
    s_mov_b64 exec, 1
    ds_add_u32 v10, v11
    s_mov_b64 exec, -1
    v_mov_b32 v10, 159812
    v_mov_b32 v11, 1
    s_mov_b64 exec, 1
    ds_add_u32 v10, v11
    s_mov_b64 exec, -1
    v_mov_b32 v10, 159752
    s_mov_b32 s10, 0x200000
aw_108:
    ds_read_b32 v11, v10
    s_waitcnt lgkmcnt(0)
    v_cmp_gt_u32 vcc, 4, v11
    s_nop 0
    s_cbranch_vccz aw_done_109
    s_sleep 1
    s_sub_u32 s10, s10, 1
    s_cbranch_scc0 aw_108
aw_done_109:
    s_mov_b32 s61, 0
wo_ph_110:
    ds_read_b64_tr_b16 v[16:17], v12 offset:0
    ds_read_b64_tr_b16 v[18:19], v12 offset:1024
    ds_read_b64_tr_b16 v[20:21], v13 offset:0
    ds_read_b64_tr_b16 v[22:23], v13 offset:1024
    ds_read_b64_tr_b16 v[24:25], v12 offset:2048
    ds_read_b64_tr_b16 v[26:27], v12 offset:3072
    ds_read_b64_tr_b16 v[28:29], v13 offset:2048
    ds_read_b64_tr_b16 v[30:31], v13 offset:3072
    s_lshl_b32 s63, s98, 7
    s_add_u32 s64, s63, 20807680
    s_lshl_b32 s52, s62, 2
    s_add_u32 s63, s63, s52
    s_add_u32 s63, s63, 20791296
    s_lshl_b32 s60, s98, 15
    s_lshl_b32 s52, s62, 12
    s_add_u32 s52, s52, s60
    s_add_u32 s52, s52, 12537856
    s_add_u32 s60, s60, 10485760
    buffer_load_dword v5, v8, s[28:31], s64 offen sc1
    s_waitcnt vmcnt(0)
    v_cmp_ne_u32 vcc, s3, v5
    v_mov_b32 v14, s3
    s_add_u32 s10, s11, 65536
    s_mov_b64 exec, 1
    buffer_store_dword v14, off, s[28:31], s10
    s_mov_b64 exec, -1
    s_cbranch_vccz poll_done_112
    s_mov_b32 s10, 0x3fffe
poll_111:
    s_and_b32 vcc_lo, s10, 15
    s_cbranch_scc0 poll_111_g
    buffer_load_dword v5, v8, s[28:31], s64 offen sc1
poll_chk_113:
    s_waitcnt vmcnt(0)
    v_cmp_ne_u32 vcc, s3, v5
    s_nop 0
    s_cbranch_vccz poll_done_112
    s_sleep 2
    s_sub_u32 s10, s10, 1
    s_cbranch_scc0 poll_111
    s_branch poll_done_112
poll_111_g:
    v_mov_b32 v5, s3
    s_mov_b64 exec, 1
    s_cmp_lg_u32 s2, 0
    s_cbranch_scc1 gf_114
    buffer_store_dword v5, off, s[28:31], s11 sc1
gf_114:
    s_mov_b64 exec, -1
    buffer_load_dword v5, v7, s[28:31], s64 offen sc1
    s_branch poll_chk_113
poll_done_112:
    buffer_load_dwordx4 v[128:131], v2, s[28:31], s60 offen offset:0 sc1
    buffer_load_dwordx4 v[132:135], v2, s[28:31], s60 offen offset:1024 sc1
    buffer_load_dwordx4 v[136:139], v2, s[28:31], s60 offen offset:2048 sc1
    buffer_load_dwordx4 v[140:143], v2, s[28:31], s60 offen offset:3072 sc1
    s_add_u32 s60, s60, 4096
    buffer_load_dwordx4 v[144:147], v2, s[28:31], s60 offen offset:0 sc1
    buffer_load_dwordx4 v[148:151], v2, s[28:31], s60 offen offset:1024 sc1
    buffer_load_dwordx4 v[152:155], v2, s[28:31], s60 offen offset:2048 sc1
    buffer_load_dwordx4 v[156:159], v2, s[28:31], s60 offen offset:3072 sc1
    s_add_u32 s60, s60, 4096
    buffer_load_dwordx4 v[160:163], v2, s[28:31], s60 offen offset:0 sc1
    buffer_load_dwordx4 v[164:167], v2, s[28:31], s60 offen offset:1024 sc1
    v_mov_b32 v14, s3
    s_mov_b64 exec, 1
    s_cmp_lg_u32 s2, 0
    s_cbranch_scc1 gf_115
    buffer_store_dword v14, off, s[28:31], s11 sc1
gf_115:
    s_mov_b64 exec, -1
    buffer_load_dwordx4 v[168:171], v2, s[28:31], s60 offen offset:2048 sc1
    s_waitcnt vmcnt(10) lgkmcnt(4)
    v_mfma_f32_32x32x16_bf16 v[64:79], v[16:19], v[128:131], 0
    ds_read_b64_tr_b16 v[32:33], v12 offset:4096
    ds_read_b64_tr_b16 v[34:35], v12 offset:5120
    ds_read_b64_tr_b16 v[36:37], v13 offset:4096
    ds_read_b64_tr_b16 v[38:39], v13 offset:5120
    v_mfma_f32_32x32x16_bf16 v[80:95], v[20:23], v[128:131], 0
    buffer_load_dwordx4 v[172:175], v2, s[28:31], s60 offen offset:3072 sc1
    s_add_u32 s60, s60, 4096
    s_waitcnt vmcnt(10) lgkmcnt(4)
    v_mfma_f32_32x32x16_bf16 v[64:79], v[24:27], v[132:135], v[64:79]
    ds_read_b64_tr_b16 v[16:17], v12 offset:6144
    ds_read_b64_tr_b16 v[18:19], v12 offset:7168
    ds_read_b64_tr_b16 v[20:21], v13 offset:6144
    ds_read_b64_tr_b16 v[22:23], v13 offset:7168
    v_mfma_f32_32x32x16_bf16 v[80:95], v[28:31], v[132:135], v[80:95]
    buffer_load_dwordx4 v[176:179], v2, s[28:31], s60 offen offset:0 sc1
    s_waitcnt vmcnt(10) lgkmcnt(4)
    v_mfma_f32_32x32x16_bf16 v[64:79], v[32:35], v[136:139], v[64:79]
    ds_read_b64_tr_b16 v[24:25], v12 offset:8192
    ds_read_b64_tr_b16 v[26:27], v12 offset:9216
    ds_read_b64_tr_b16 v[28:29], v13 offset:8192
    ds_read_b64_tr_b16 v[30:31], v13 offset:9216
    v_mfma_f32_32x32x16_bf16 v[80:95], v[36:39], v[136:139], v[80:95]
    buffer_load_dwordx4 v[180:183], v2, s[28:31], s60 offen offset:1024 sc1
    s_waitcnt vmcnt(10) lgkmcnt(4)
    v_mfma_f32_32x32x16_bf16 v[64:79], v[16:19], v[140:143], v[64:79]
    ds_read_b64_tr_b16 v[32:33], v12 offset:10240
    ds_read_b64_tr_b16 v[34:35], v12 offset:11264
    ds_read_b64_tr_b16 v[36:37], v13 offset:10240
    ds_read_b64_tr_b16 v[38:39], v13 offset:11264
    v_mfma_f32_32x32x16_bf16 v[80:95], v[20:23], v[140:143], v[80:95]
    buffer_load_dwordx4 v[184:187], v2, s[28:31], s60 offen offset:2048 sc1
    s_waitcnt vmcnt(10) lgkmcnt(4)
    v_mfma_f32_32x32x16_bf16 v[64:79], v[24:27], v[144:147], v[64:79]
    ds_read_b64_tr_b16 v[16:17], v12 offset:12288
    ds_read_b64_tr_b16 v[18:19], v12 offset:13312
    ds_read_b64_tr_b16 v[20:21], v13 offset:12288
    ds_read_b64_tr_b16 v[22:23], v13 offset:13312
    v_mfma_f32_32x32x16_bf16 v[80:95], v[28:31], v[144:147], v[80:95]
    buffer_load_dwordx4 v[188:191], v2, s[28:31], s60 offen offset:3072 sc1
    s_add_u32 s60, s60, 4096
    s_waitcnt vmcnt(10) lgkmcnt(4)
    v_mfma_f32_32x32x16_bf16 v[64:79], v[32:35], v[148:151], v[64:79]
    ds_read_b64_tr_b16 v[24:25], v12 offset:14336
    ds_read_b64_tr_b16 v[26:27], v12 offset:15360
    ds_read_b64_tr_b16 v[28:29], v13 offset:14336
    ds_read_b64_tr_b16 v[30:31], v13 offset:15360
    v_mfma_f32_32x32x16_bf16 v[80:95], v[36:39], v[148:151], v[80:95]
    buffer_load_dwordx4 v[192:195], v2, s[28:31], s60 offen offset:0 sc1
    s_waitcnt vmcnt(10) lgkmcnt(4)
    v_mfma_f32_32x32x16_bf16 v[64:79], v[16:19], v[152:155], v[64:79]
    ds_read_b64_tr_b16 v[32:33], v12 offset:16384
    ds_read_b64_tr_b16 v[34:35], v12 offset:17408
    ds_read_b64_tr_b16 v[36:37], v13 offset:16384
    ds_read_b64_tr_b16 v[38:39], v13 offset:17408
    v_mfma_f32_32x32x16_bf16 v[80:95], v[20:23], v[152:155], v[80:95]
    buffer_load_dwordx4 v[196:199], v2, s[28:31], s60 offen offset:1024 sc1
    s_waitcnt vmcnt(10) lgkmcnt(4)
    v_mfma_f32_32x32x16_bf16 v[64:79], v[24:27], v[156:159], v[64:79]
    ds_read_b64_tr_b16 v[16:17], v12 offset:18432
    ds_read_b64_tr_b16 v[18:19], v12 offset:19456
    ds_read_b64_tr_b16 v[20:21], v13 offset:18432
    ds_read_b64_tr_b16 v[22:23], v13 offset:19456
    v_mfma_f32_32x32x16_bf16 v[80:95], v[28:31], v[156:159], v[80:95]
    buffer_load_dwordx4 v[200:203], v2, s[28:31], s60 offen offset:2048 sc1
    s_waitcnt vmcnt(10) lgkmcnt(4)
    v_mfma_f32_32x32x16_bf16 v[64:79], v[32:35], v[160:163], v[64:79]
    ds_read_b64_tr_b16 v[24:25], v12 offset:20480
    ds_read_b64_tr_b16 v[26:27], v12 offset:21504
    ds_read_b64_tr_b16 v[28:29], v13 offset:20480
    ds_read_b64_tr_b16 v[30:31], v13 offset:21504
    v_mfma_f32_32x32x16_bf16 v[80:95], v[36:39], v[160:163], v[80:95]
    buffer_load_dwordx4 v[204:207], v2, s[28:31], s60 offen offset:3072 sc1
    s_add_u32 s60, s60, 4096
    s_waitcnt vmcnt(10) lgkmcnt(4)
    v_mfma_f32_32x32x16_bf16 v[64:79], v[16:19], v[164:167], v[64:79]
    ds_read_b64_tr_b16 v[32:33], v12 offset:22528
    ds_read_b64_tr_b16 v[34:35], v12 offset:23552
    ds_read_b64_tr_b16 v[36:37], v13 offset:22528
    ds_read_b64_tr_b16 v[38:39], v13 offset:23552
    v_mfma_f32_32x32x16_bf16 v[80:95], v[20:23], v[164:167], v[80:95]
    buffer_load_dwordx4 v[208:211], v2, s[28:31], s60 offen offset:0 sc1
    s_waitcnt vmcnt(10) lgkmcnt(4)
    v_mfma_f32_32x32x16_bf16 v[64:79], v[24:27], v[168:171], v[64:79]
    ds_read_b64_tr_b16 v[16:17], v12 offset:24576
    ds_read_b64_tr_b16 v[18:19], v12 offset:25600
    ds_read_b64_tr_b16 v[20:21], v13 offset:24576
    ds_read_b64_tr_b16 v[22:23], v13 offset:25600
    v_mfma_f32_32x32x16_bf16 v[80:95], v[28:31], v[168:171], v[80:95]
    buffer_load_dwordx4 v[212:215], v2, s[28:31], s60 offen offset:1024 sc1
    s_waitcnt vmcnt(10) lgkmcnt(4)
    v_mfma_f32_32x32x16_bf16 v[64:79], v[32:35], v[172:175], v[64:79]
    ds_read_b64_tr_b16 v[24:25], v12 offset:26624
    ds_read_b64_tr_b16 v[26:27], v12 offset:27648
    ds_read_b64_tr_b16 v[28:29], v13 offset:26624
    ds_read_b64_tr_b16 v[30:31], v13 offset:27648
    v_mfma_f32_32x32x16_bf16 v[80:95], v[36:39], v[172:175], v[80:95]
    buffer_load_dwordx4 v[216:219], v2, s[28:31], s60 offen offset:2048 sc1
    s_waitcnt vmcnt(10) lgkmcnt(4)
    v_mfma_f32_32x32x16_bf16 v[64:79], v[16:19], v[176:179], v[64:79]
    ds_read_b64_tr_b16 v[32:33], v12 offset:28672
    ds_read_b64_tr_b16 v[34:35], v12 offset:29696
    ds_read_b64_tr_b16 v[36:37], v13 offset:28672
    ds_read_b64_tr_b16 v[38:39], v13 offset:29696
    v_mfma_f32_32x32x16_bf16 v[80:95], v[20:23], v[176:179], v[80:95]
    buffer_load_dwordx4 v[220:223], v2, s[28:31], s60 offen offset:3072 sc1
    s_add_u32 s60, s60, 4096
    s_waitcnt vmcnt(10) lgkmcnt(4)
    v_mfma_f32_32x32x16_bf16 v[64:79], v[24:27], v[180:183], v[64:79]
    ds_read_b64_tr_b16 v[16:17], v12 offset:30720
    ds_read_b64_tr_b16 v[18:19], v12 offset:31744
    ds_read_b64_tr_b16 v[20:21], v13 offset:30720
    ds_read_b64_tr_b16 v[22:23], v13 offset:31744
    v_mfma_f32_32x32x16_bf16 v[80:95], v[28:31], v[180:183], v[80:95]
    buffer_load_dwordx4 v[224:227], v2, s[28:31], s60 offen offset:0 sc1
    s_waitcnt vmcnt(10) lgkmcnt(4)
    v_mfma_f32_32x32x16_bf16 v[64:79], v[32:35], v[184:187], v[64:79]
    ds_read_b64_tr_b16 v[24:25], v12 offset:32768
    ds_read_b64_tr_b16 v[26:27], v12 offset:33792
    ds_read_b64_tr_b16 v[28:29], v13 offset:32768
    ds_read_b64_tr_b16 v[30:31], v13 offset:33792
    v_mfma_f32_32x32x16_bf16 v[80:95], v[36:39], v[184:187], v[80:95]
    buffer_load_dwordx4 v[228:231], v2, s[28:31], s60 offen offset:1024 sc1
    s_waitcnt vmcnt(10) lgkmcnt(4)
    v_mfma_f32_32x32x16_bf16 v[64:79], v[16:19], v[188:191], v[64:79]
    ds_read_b64_tr_b16 v[32:33], v12 offset:34816
    ds_read_b64_tr_b16 v[34:35], v12 offset:35840
    ds_read_b64_tr_b16 v[36:37], v13 offset:34816
    ds_read_b64_tr_b16 v[38:39], v13 offset:35840
    v_mfma_f32_32x32x16_bf16 v[80:95], v[20:23], v[188:191], v[80:95]
    buffer_load_dwordx4 v[232:235], v2, s[28:31], s60 offen offset:2048 sc1
    s_cmp_eq_u32 s61, 0
    s_cselect_b32 s53, -20, 0
    s_add_u32 s53, s53, 159816
    v_mov_b32 v10, s53
    v_mov_b32 v11, 1
    s_mov_b64 exec, 1
    ds_add_u32 v10, v11
    s_mov_b64 exec, -1
    s_waitcnt vmcnt(10) lgkmcnt(5)
    v_mfma_f32_32x32x16_bf16 v[64:79], v[24:27], v[192:195], v[64:79]
    ds_read_b64_tr_b16 v[16:17], v12 offset:36864
    ds_read_b64_tr_b16 v[18:19], v12 offset:37888
    ds_read_b64_tr_b16 v[20:21], v13 offset:36864
    ds_read_b64_tr_b16 v[22:23], v13 offset:37888
    v_mfma_f32_32x32x16_bf16 v[80:95], v[28:31], v[192:195], v[80:95]
    buffer_load_dwordx4 v[236:239], v2, s[28:31], s60 offen offset:3072 sc1
    s_add_u32 s60, s60, 4096
    s_waitcnt vmcnt(10) lgkmcnt(5)
    v_mfma_f32_32x32x16_bf16 v[64:79], v[32:35], v[196:199], v[64:79]
    ds_read_b64_tr_b16 v[24:25], v12 offset:38912
    ds_read_b64_tr_b16 v[26:27], v12 offset:39936
    ds_read_b64_tr_b16 v[28:29], v13 offset:38912
    ds_read_b64_tr_b16 v[30:31], v13 offset:39936
    v_mfma_f32_32x32x16_bf16 v[80:95], v[36:39], v[196:199], v[80:95]
    buffer_load_dwordx4 v[240:243], v2, s[28:31], s60 offen offset:0 sc1
    s_waitcnt vmcnt(10) lgkmcnt(4)
    v_mfma_f32_32x32x16_bf16 v[64:79], v[16:19], v[200:203], v[64:79]
    ds_read_b64_tr_b16 v[32:33], v12 offset:40960
    ds_read_b64_tr_b16 v[34:35], v12 offset:41984
    ds_read_b64_tr_b16 v[36:37], v13 offset:40960
    ds_read_b64_tr_b16 v[38:39], v13 offset:41984
    v_mfma_f32_32x32x16_bf16 v[80:95], v[20:23], v[200:203], v[80:95]
    buffer_load_dwordx4 v[244:247], v2, s[28:31], s60 offen offset:1024 sc1
    s_waitcnt vmcnt(10) lgkmcnt(4)
    v_mfma_f32_32x32x16_bf16 v[64:79], v[24:27], v[204:207], v[64:79]
    ds_read_b64_tr_b16 v[16:17], v12 offset:43008
    ds_read_b64_tr_b16 v[18:19], v12 offset:44032
    ds_read_b64_tr_b16 v[20:21], v13 offset:43008
    ds_read_b64_tr_b16 v[22:23], v13 offset:44032
    v_mfma_f32_32x32x16_bf16 v[80:95], v[28:31], v[204:207], v[80:95]
    buffer_load_dwordx4 v[248:251], v2, s[28:31], s60 offen offset:2048 sc1
    s_waitcnt vmcnt(10) lgkmcnt(4)
    v_mfma_f32_32x32x16_bf16 v[64:79], v[32:35], v[208:211], v[64:79]
    ds_read_b64_tr_b16 v[24:25], v12 offset:45056
    ds_read_b64_tr_b16 v[26:27], v12 offset:46080
    ds_read_b64_tr_b16 v[28:29], v13 offset:45056
    ds_read_b64_tr_b16 v[30:31], v13 offset:46080
    v_mfma_f32_32x32x16_bf16 v[80:95], v[36:39], v[208:211], v[80:95]
    buffer_load_dwordx4 v[252:255], v2, s[28:31], s60 offen offset:3072 sc1
    s_waitcnt vmcnt(10) lgkmcnt(4)
    v_mfma_f32_32x32x16_bf16 v[64:79], v[16:19], v[212:215], v[64:79]
    ds_read_b64_tr_b16 v[32:33], v12 offset:47104
    ds_read_b64_tr_b16 v[34:35], v12 offset:48128
    ds_read_b64_tr_b16 v[36:37], v13 offset:47104
    ds_read_b64_tr_b16 v[38:39], v13 offset:48128
    v_mfma_f32_32x32x16_bf16 v[80:95], v[20:23], v[212:215], v[80:95]
    v_mov_b32 v10, 159776
    v_mov_b32 v11, 1
    s_mov_b64 exec, 1
    ds_add_u32 v10, v11
    s_mov_b64 exec, -1
    s_waitcnt vmcnt(9) lgkmcnt(5)
    v_mfma_f32_32x32x16_bf16 v[64:79], v[24:27], v[216:219], v[64:79]
    ds_read_b64_tr_b16 v[16:17], v12 offset:49152
    ds_read_b64_tr_b16 v[18:19], v12 offset:50176
    ds_read_b64_tr_b16 v[20:21], v13 offset:49152
    ds_read_b64_tr_b16 v[22:23], v13 offset:50176
    v_mfma_f32_32x32x16_bf16 v[80:95], v[28:31], v[216:219], v[80:95]
    s_waitcnt vmcnt(8) lgkmcnt(5)
    v_mfma_f32_32x32x16_bf16 v[64:79], v[32:35], v[220:223], v[64:79]
    ds_read_b64_tr_b16 v[24:25], v12 offset:51200
    ds_read_b64_tr_b16 v[26:27], v12 offset:52224
    ds_read_b64_tr_b16 v[28:29], v13 offset:51200
    ds_read_b64_tr_b16 v[30:31], v13 offset:52224
    v_mfma_f32_32x32x16_bf16 v[80:95], v[36:39], v[220:223], v[80:95]
    s_waitcnt vmcnt(7) lgkmcnt(4)
    v_mfma_f32_32x32x16_bf16 v[64:79], v[16:19], v[224:227], v[64:79]
    ds_read_b64_tr_b16 v[32:33], v12 offset:53248
    ds_read_b64_tr_b16 v[34:35], v12 offset:54272
    ds_read_b64_tr_b16 v[36:37], v13 offset:53248
    ds_read_b64_tr_b16 v[38:39], v13 offset:54272
    v_mfma_f32_32x32x16_bf16 v[80:95], v[20:23], v[224:227], v[80:95]
    s_waitcnt vmcnt(6) lgkmcnt(4)
    v_mfma_f32_32x32x16_bf16 v[64:79], v[24:27], v[228:231], v[64:79]
    ds_read_b64_tr_b16 v[16:17], v12 offset:55296
    ds_read_b64_tr_b16 v[18:19], v12 offset:56320
    ds_read_b64_tr_b16 v[20:21], v13 offset:55296
    ds_read_b64_tr_b16 v[22:23], v13 offset:56320
    v_mfma_f32_32x32x16_bf16 v[80:95], v[28:31], v[228:231], v[80:95]
    s_waitcnt vmcnt(5) lgkmcnt(4)
    v_mfma_f32_32x32x16_bf16 v[64:79], v[32:35], v[232:235], v[64:79]
    ds_read_b64_tr_b16 v[24:25], v12 offset:57344
    ds_read_b64_tr_b16 v[26:27], v12 offset:58368
    ds_read_b64_tr_b16 v[28:29], v13 offset:57344
    ds_read_b64_tr_b16 v[30:31], v13 offset:58368
    v_mfma_f32_32x32x16_bf16 v[80:95], v[36:39], v[232:235], v[80:95]
    s_waitcnt vmcnt(4) lgkmcnt(4)
    v_mfma_f32_32x32x16_bf16 v[64:79], v[16:19], v[236:239], v[64:79]
    ds_read_b64_tr_b16 v[32:33], v12 offset:59392
    ds_read_b64_tr_b16 v[34:35], v12 offset:60416
    ds_read_b64_tr_b16 v[36:37], v13 offset:59392
    ds_read_b64_tr_b16 v[38:39], v13 offset:60416
    v_mfma_f32_32x32x16_bf16 v[80:95], v[20:23], v[236:239], v[80:95]
    s_waitcnt vmcnt(3) lgkmcnt(4)
    v_mfma_f32_32x32x16_bf16 v[64:79], v[24:27], v[240:243], v[64:79]
    ds_read_b64_tr_b16 v[16:17], v12 offset:61440
    ds_read_b64_tr_b16 v[18:19], v12 offset:62464
    ds_read_b64_tr_b16 v[20:21], v13 offset:61440
    ds_read_b64_tr_b16 v[22:23], v13 offset:62464
    v_mfma_f32_32x32x16_bf16 v[80:95], v[28:31], v[240:243], v[80:95]
    s_waitcnt vmcnt(2) lgkmcnt(4)
    v_mfma_f32_32x32x16_bf16 v[64:79], v[32:35], v[244:247], v[64:79]
    ds_read_b64_tr_b16 v[24:25], v12 offset:63488
    ds_read_b64_tr_b16 v[26:27], v12 offset:64512
    ds_read_b64_tr_b16 v[28:29], v13 offset:63488
    ds_read_b64_tr_b16 v[30:31], v13 offset:64512
    v_mfma_f32_32x32x16_bf16 v[80:95], v[36:39], v[244:247], v[80:95]
    s_waitcnt vmcnt(1) lgkmcnt(4)
    v_mfma_f32_32x32x16_bf16 v[64:79], v[16:19], v[248:251], v[64:79]
    v_mfma_f32_32x32x16_bf16 v[80:95], v[20:23], v[248:251], v[80:95]
    s_waitcnt vmcnt(0) lgkmcnt(0)
    v_mfma_f32_32x32x16_bf16 v[64:79], v[24:27], v[252:255], v[64:79]
    v_mfma_f32_32x32x16_bf16 v[80:95], v[28:31], v[252:255], v[80:95]
    s_cmp_eq_u32 s61, 0
    s_cbranch_scc1 wo_nx_116
    v_mov_b32 v10, 159820
    v_mov_b32 v11, 1
    s_mov_b64 exec, 1
    ds_add_u32 v10, v11
    s_mov_b64 exec, -1
wo_nx_116:
    s_nop 8
    v_cvt_pk_bf16_f32 v96, v64, v65
    v_cvt_pk_bf16_f32 v97, v66, v67
    v_cvt_pk_bf16_f32 v98, v68, v69
    v_cvt_pk_bf16_f32 v99, v70, v71
    v_cvt_pk_bf16_f32 v100, v72, v73
    v_cvt_pk_bf16_f32 v101, v74, v75
    v_cvt_pk_bf16_f32 v102, v76, v77
    v_cvt_pk_bf16_f32 v103, v78, v79
    buffer_store_dwordx4 v[96:99], v2, s[28:31], s52 offen sc1
    buffer_store_dwordx4 v[100:103], v2, s[28:31], s52 offen offset:1024 sc1
    v_cvt_pk_bf16_f32 v104, v80, v81
    v_cvt_pk_bf16_f32 v105, v82, v83
    v_cvt_pk_bf16_f32 v106, v84, v85
    v_cvt_pk_bf16_f32 v107, v86, v87
    v_cvt_pk_bf16_f32 v108, v88, v89
    v_cvt_pk_bf16_f32 v109, v90, v91
    v_cvt_pk_bf16_f32 v110, v92, v93
    v_cvt_pk_bf16_f32 v111, v94, v95
    buffer_store_dwordx4 v[104:107], v2, s[28:31], s52 offen offset:2048 sc1
    buffer_store_dwordx4 v[108:111], v2, s[28:31], s52 offen offset:3072 sc1
    s_cmp_lg_u32 s61, 0
    s_cbranch_scc1 P3done_92
    s_mov_b32 s11, s63
    s_mov_b32 s61, 1
    s_add_u32 s98, s98, 4
    s_waitcnt lgkmcnt(0)
    s_branch wo_ph_110
P3done_92:
    s_waitcnt vmcnt(0)
    v_mov_b32 v5, s3
    s_add_u32 s10, s63, 65536
    s_mov_b64 exec, 1
    buffer_store_dword v5, off, s[28:31], s10
    s_cmp_lg_u32 s2, 0
    s_cbranch_scc1 gf_117
    buffer_store_dword v5, off, s[28:31], s63 sc1
gf_117:
    s_mov_b64 exec, -1
    s_branch P3end_118
P3idle_90:
    v_mov_b32 v5, s3
    s_mov_b64 exec, 1
    s_cmp_lg_u32 s2, 0
    s_cbranch_scc1 gf_119
    buffer_store_dword v5, off, s[28:31], s11 sc1
gf_119:
    s_mov_b64 exec, -1
    s_mov_b32 m0, s59
    s_add_u32 s59, s59, 4096
    buffer_load_dwordx4 v9, s[40:43], s58 offen lds
    s_add_u32 s58, s58, s56
    s_mov_b32 m0, s59
    s_add_u32 s59, s59, 4096
    buffer_load_dwordx4 v9, s[40:43], s58 offen lds
    s_add_u32 s58, s58, s56
    s_mov_b32 m0, s59
    s_add_u32 s59, s59, 4096
    buffer_load_dwordx4 v9, s[40:43], s58 offen lds
    s_add_u32 s58, s58, s56
    s_mov_b32 m0, s59
    s_add_u32 s59, s59, 4096
    buffer_load_dwordx4 v9, s[40:43], s58 offen lds
    s_add_u32 s58, s58, s56
    s_mov_b32 m0, s59
    s_add_u32 s59, s59, 4096
    buffer_load_dwordx4 v9, s[40:43], s58 offen lds
    s_add_u32 s58, s58, s56
    s_mov_b32 m0, s59
    s_add_u32 s59, s59, 4096
    buffer_load_dwordx4 v9, s[40:43], s58 offen lds
    s_add_u32 s58, s58, s56
    s_mov_b32 m0, s59
    s_add_u32 s59, s59, 4096
    buffer_load_dwordx4 v9, s[40:43], s58 offen lds
    s_add_u32 s58, s58, s56
    s_mov_b32 m0, s59
    s_add_u32 s59, s59, 4096
    buffer_load_dwordx4 v9, s[40:43], s58 offen lds
    s_add_u32 s58, s58, s56
    s_mov_b32 m0, s59
    s_add_u32 s59, s59, 4096
    buffer_load_dwordx4 v9, s[40:43], s58 offen lds
    s_add_u32 s58, s58, s56
    s_mov_b32 m0, s59
    s_add_u32 s59, s59, 4096
    buffer_load_dwordx4 v9, s[40:43], s58 offen lds
    s_add_u32 s58, s58, s56
    s_mov_b32 m0, s59
    s_add_u32 s59, s59, 4096
    buffer_load_dwordx4 v9, s[40:43], s58 offen lds
    s_add_u32 s58, s58, s56
    s_mov_b32 m0, s59
    s_add_u32 s59, s59, 4096
    buffer_load_dwordx4 v9, s[40:43], s58 offen lds
    s_add_u32 s58, s58, s56
    s_mov_b32 m0, s59
    s_add_u32 s59, s59, 4096
    buffer_load_dwordx4 v9, s[40:43], s58 offen lds
    s_add_u32 s58, s58, s56
    s_mov_b32 m0, s59
    s_add_u32 s59, s59, 4096
    buffer_load_dwordx4 v9, s[40:43], s58 offen lds
    s_add_u32 s58, s58, s56
    s_mov_b32 m0, s59
    s_add_u32 s59, s59, 4096
    buffer_load_dwordx4 v9, s[40:43], s58 offen lds
    s_add_u32 s58, s58, s56
    s_mov_b32 s10, 0x200000
aw_120:
    v_mov_b32 v10, 159744
    ds_read_b64 v[10:11], v10
    s_waitcnt lgkmcnt(0)
    v_cmp_gt_u32 vcc, 8, v10
    v_cmp_gt_u32 s[54:55], 4, v11
    s_nop 0
    s_or_b64 vcc, vcc, s[54:55]
    s_cbranch_vccz aw_done_121
    s_sleep 1
    s_sub_u32 s10, s10, 1
    s_cbranch_scc0 aw_120
aw_done_121:
    s_mov_b32 m0, s59
    s_add_u32 s59, s59, 4096
    buffer_load_dwordx4 v9, s[40:43], s58 offen lds
    s_add_u32 s58, s58, s56
    s_mov_b32 m0, s59
    s_add_u32 s59, s59, 4096
    buffer_load_dwordx4 v9, s[40:43], s58 offen lds
    s_add_u32 s58, s58, s56
    s_mov_b32 m0, s59
    s_add_u32 s59, s59, 4096
    buffer_load_dwordx4 v9, s[40:43], s58 offen lds
    s_add_u32 s58, s58, s56
    s_mov_b32 m0, s59
    s_add_u32 s59, s59, 4096
    buffer_load_dwordx4 v9, s[40:43], s58 offen lds
    s_add_u32 s58, s58, s56
    s_lshl_b32 s59, s44, 10
    s_mov_b32 m0, s59
    s_add_u32 s59, s59, 4096
    buffer_load_dwordx4 v9, s[40:43], s58 offen lds
    s_add_u32 s58, s58, s56
    v_bfe_u32 v5, v1, 2, 2
    v_lshlrev_b32 v12, 2, v4
    v_add_u32 v12, v12, v5
    v_lshlrev_b32 v12, 8, v12
    v_xor_b32 v5, s44, v5
    v_lshl_add_u32 v12, v5, 6, v12
    v_bfe_u32 v5, v1, 4, 1
    v_lshl_add_u32 v12, v5, 5, v12
    v_and_b32 v5, 3, v1
    v_lshl_add_u32 v12, v5, 3, v12
    v_mov_b32 v16, 0x3f803f80
    v_mov_b32 v17, 0x3f803f80
    v_mov_b32 v18, 0x3f803f80
    v_mov_b32 v19, 0x3f803f80
    s_waitcnt vmcnt(0)
    v_mov_b32 v10, 159752
    v_mov_b32 v11, 1
    s_mov_b64 exec, 1
    ds_add_u32 v10, v11
    s_mov_b64 exec, -1
    v_mov_b32 v10, 159752
    s_mov_b32 s10, 0x200000
aw_122:
    ds_read_b32 v11, v10
    s_waitcnt lgkmcnt(0)
    v_cmp_gt_u32 vcc, 4, v11
    s_nop 0
    s_cbranch_vccz aw_done_123
    s_sleep 1
    s_sub_u32 s10, s10, 1
    s_cbranch_scc0 aw_122
aw_done_123:
    ds_read_b64_tr_b16 v[128:129], v12 offset:32768
    ds_read_b64_tr_b16 v[130:131], v12 offset:34816
    ds_read_b64_tr_b16 v[132:133], v12 offset:36864
    ds_read_b64_tr_b16 v[134:135], v12 offset:38912
    ds_read_b64_tr_b16 v[136:137], v12 offset:40960
    ds_read_b64_tr_b16 v[138:139], v12 offset:43008
    ds_read_b64_tr_b16 v[140:141], v12 offset:45056
    ds_read_b64_tr_b16 v[142:143], v12 offset:47104
    ds_read_b64_tr_b16 v[144:145], v12 offset:49152
    ds_read_b64_tr_b16 v[146:147], v12 offset:51200
    ds_read_b64_tr_b16 v[148:149], v12 offset:53248
    ds_read_b64_tr_b16 v[150:151], v12 offset:55296
    v_add_u32 v12, 0xe000, v12
    ds_read_b64_tr_b16 v[152:153], v12 offset:0
    ds_read_b64_tr_b16 v[154:155], v12 offset:2048
    s_waitcnt lgkmcnt(12)
    v_mfma_f32_32x32x16_bf16 v[64:79], v[16:19], v[128:131], 0
    ds_read_b64_tr_b16 v[156:157], v12 offset:4096
    ds_read_b64_tr_b16 v[158:159], v12 offset:6144
    s_waitcnt lgkmcnt(12)
    v_mfma_f32_32x32x16_bf16 v[64:79], v[16:19], v[132:135], v[64:79]
    ds_read_b64_tr_b16 v[160:161], v12 offset:8192
    ds_read_b64_tr_b16 v[162:163], v12 offset:10240
    s_waitcnt lgkmcnt(12)
    v_mfma_f32_32x32x16_bf16 v[64:79], v[16:19], v[136:139], v[64:79]
    ds_read_b64_tr_b16 v[164:165], v12 offset:12288
    ds_read_b64_tr_b16 v[166:167], v12 offset:14336
    s_waitcnt lgkmcnt(12)
    v_mfma_f32_32x32x16_bf16 v[64:79], v[16:19], v[140:143], v[64:79]
    ds_read_b64_tr_b16 v[168:169], v12 offset:16384
    ds_read_b64_tr_b16 v[170:171], v12 offset:18432
    s_waitcnt lgkmcnt(12)
    v_mfma_f32_32x32x16_bf16 v[64:79], v[16:19], v[144:147], v[64:79]
    ds_read_b64_tr_b16 v[172:173], v12 offset:20480
    ds_read_b64_tr_b16 v[174:175], v12 offset:22528
    s_waitcnt lgkmcnt(12)
    v_mfma_f32_32x32x16_bf16 v[64:79], v[16:19], v[148:151], v[64:79]
    ds_read_b64_tr_b16 v[176:177], v12 offset:24576
    ds_read_b64_tr_b16 v[178:179], v12 offset:26624
    s_waitcnt lgkmcnt(12)
    v_mfma_f32_32x32x16_bf16 v[64:79], v[16:19], v[152:155], v[64:79]
    ds_read_b64_tr_b16 v[180:181], v12 offset:28672
    ds_read_b64_tr_b16 v[182:183], v12 offset:30720
    s_waitcnt lgkmcnt(12)
    v_mfma_f32_32x32x16_bf16 v[64:79], v[16:19], v[156:159], v[64:79]
    ds_read_b64_tr_b16 v[184:185], v12 offset:32768
    ds_read_b64_tr_b16 v[186:187], v12 offset:34816
    s_waitcnt lgkmcnt(12)
    v_mfma_f32_32x32x16_bf16 v[64:79], v[16:19], v[160:163], v[64:79]
    ds_read_b64_tr_b16 v[188:189], v12 offset:36864
    ds_read_b64_tr_b16 v[190:191], v12 offset:38912
    s_waitcnt lgkmcnt(12)
    v_mfma_f32_32x32x16_bf16 v[64:79], v[16:19], v[164:167], v[64:79]
    ds_read_b64_tr_b16 v[192:193], v12 offset:40960
    ds_read_b64_tr_b16 v[194:195], v12 offset:43008
    s_waitcnt lgkmcnt(12)
    v_mfma_f32_32x32x16_bf16 v[64:79], v[16:19], v[168:171], v[64:79]
    ds_read_b64_tr_b16 v[196:197], v12 offset:45056
    ds_read_b64_tr_b16 v[198:199], v12 offset:47104
    s_waitcnt lgkmcnt(12)
    v_mfma_f32_32x32x16_bf16 v[64:79], v[16:19], v[172:175], v[64:79]
    ds_read_b64_tr_b16 v[200:201], v12 offset:49152
    ds_read_b64_tr_b16 v[202:203], v12 offset:51200
    s_waitcnt lgkmcnt(12)
    v_mfma_f32_32x32x16_bf16 v[64:79], v[16:19], v[176:179], v[64:79]
    ds_read_b64_tr_b16 v[204:205], v12 offset:53248
    ds_read_b64_tr_b16 v[206:207], v12 offset:55296
    s_waitcnt lgkmcnt(12)
    v_mfma_f32_32x32x16_bf16 v[64:79], v[16:19], v[180:183], v[64:79]
    v_add_u32 v12, 0xe000, v12
    ds_read_b64_tr_b16 v[208:209], v12 offset:0
    ds_read_b64_tr_b16 v[210:211], v12 offset:2048
    s_waitcnt lgkmcnt(12)
    v_mfma_f32_32x32x16_bf16 v[64:79], v[16:19], v[184:187], v[64:79]
    ds_read_b64_tr_b16 v[212:213], v12 offset:4096
    ds_read_b64_tr_b16 v[214:215], v12 offset:6144
    s_waitcnt lgkmcnt(12)
    v_mfma_f32_32x32x16_bf16 v[64:79], v[16:19], v[188:191], v[64:79]
    ds_read_b64_tr_b16 v[216:217], v12 offset:8192
    ds_read_b64_tr_b16 v[218:219], v12 offset:10240
    s_waitcnt lgkmcnt(12)
    v_mfma_f32_32x32x16_bf16 v[64:79], v[16:19], v[192:195], v[64:79]
    ds_read_b64_tr_b16 v[220:221], v12 offset:12288
    ds_read_b64_tr_b16 v[222:223], v12 offset:14336
    s_waitcnt lgkmcnt(12)
    v_mfma_f32_32x32x16_bf16 v[64:79], v[16:19], v[196:199], v[64:79]
    ds_read_b64_tr_b16 v[224:225], v12 offset:16384
    ds_read_b64_tr_b16 v[226:227], v12 offset:18432
    s_waitcnt lgkmcnt(12)
    v_mfma_f32_32x32x16_bf16 v[64:79], v[16:19], v[200:203], v[64:79]
    ds_read_b64_tr_b16 v[228:229], v12 offset:20480
    ds_read_b64_tr_b16 v[230:231], v12 offset:22528
    s_waitcnt lgkmcnt(12)
    v_mfma_f32_32x32x16_bf16 v[64:79], v[16:19], v[204:207], v[64:79]
    ds_read_b64_tr_b16 v[232:233], v12 offset:24576
    ds_read_b64_tr_b16 v[234:235], v12 offset:26624
    s_waitcnt lgkmcnt(12)
    v_mfma_f32_32x32x16_bf16 v[64:79], v[16:19], v[208:211], v[64:79]
    ds_read_b64_tr_b16 v[236:237], v12 offset:28672
    ds_read_b64_tr_b16 v[238:239], v12 offset:30720
    s_waitcnt lgkmcnt(12)
    v_mfma_f32_32x32x16_bf16 v[64:79], v[16:19], v[212:215], v[64:79]
    ds_read_b64_tr_b16 v[240:241], v12 offset:32768
    ds_read_b64_tr_b16 v[242:243], v12 offset:34816
    s_waitcnt lgkmcnt(12)
    v_mfma_f32_32x32x16_bf16 v[64:79], v[16:19], v[216:219], v[64:79]
    ds_read_b64_tr_b16 v[244:245], v12 offset:36864
    ds_read_b64_tr_b16 v[246:247], v12 offset:38912
    s_waitcnt lgkmcnt(12)
    v_mfma_f32_32x32x16_bf16 v[64:79], v[16:19], v[220:223], v[64:79]
    ds_read_b64_tr_b16 v[248:249], v12 offset:40960
    ds_read_b64_tr_b16 v[250:251], v12 offset:43008
    s_waitcnt lgkmcnt(12)
    v_mfma_f32_32x32x16_bf16 v[64:79], v[16:19], v[224:227], v[64:79]
    v_add_u32 v12, 0xfffe4000, v12
    ds_read_b64_tr_b16 v[252:253], v12 offset:0
    ds_read_b64_tr_b16 v[254:255], v12 offset:2048
    s_waitcnt lgkmcnt(12)
    v_mfma_f32_32x32x16_bf16 v[64:79], v[16:19], v[228:231], v[64:79]
    s_waitcnt lgkmcnt(10)
    v_mfma_f32_32x32x16_bf16 v[64:79], v[16:19], v[232:235], v[64:79]
    s_waitcnt lgkmcnt(8)
    v_mfma_f32_32x32x16_bf16 v[64:79], v[16:19], v[236:239], v[64:79]
    s_waitcnt lgkmcnt(6)
    v_mfma_f32_32x32x16_bf16 v[64:79], v[16:19], v[240:243], v[64:79]
    s_waitcnt lgkmcnt(4)
    v_mfma_f32_32x32x16_bf16 v[64:79], v[16:19], v[244:247], v[64:79]
    s_waitcnt lgkmcnt(2)
    v_mfma_f32_32x32x16_bf16 v[64:79], v[16:19], v[248:251], v[64:79]
    s_waitcnt lgkmcnt(0)
    v_mfma_f32_32x32x16_bf16 v[64:79], v[16:19], v[252:255], v[64:79]
    v_mov_b32 v10, 159776
    v_mov_b32 v11, 1
    s_mov_b64 exec, 1
    ds_add_u32 v10, v11
    s_mov_b64 exec, -1
    v_mov_b32 v10, 159808
    v_mov_b32 v11, 1
    s_mov_b64 exec, 1
    ds_add_u32 v10, v11
    s_mov_b64 exec, -1
    v_mov_b32 v10, 159812
    v_mov_b32 v11, 1
    s_mov_b64 exec, 1
    ds_add_u32 v10, v11
    s_mov_b64 exec, -1
    v_mov_b32 v10, 159816
    v_mov_b32 v11, 1
    s_mov_b64 exec, 1
    ds_add_u32 v10, v11
    s_mov_b64 exec, -1
    v_mov_b32 v10, 159820
    v_mov_b32 v11, 1
    s_mov_b64 exec, 1
    ds_add_u32 v10, v11
    s_mov_b64 exec, -1
    v_cvt_pk_bf16_f32 v21, v64, 0
    v_lshlrev_b32 v22, 16, v21
    v_sub_f32 v22, v64, v22
    v_cvt_pk_bf16_f32 v20, v64, v22
    v_mov_b32 v22, 0
    v_mov_b32 v23, s3
    s_lshl_b32 s52, s97, 2
    s_add_u32 s52, s52, s44
    s_lshl_b32 s52, s52, 9
    s_add_u32 s52, s52, 20643840
    s_mov_b32 exec_hi, 0
    buffer_store_dwordx4 v[20:23], v2, s[28:31], s52 offen sc1
    s_mov_b64 exec, -1
P3end_118:
L_end:
    s_endpgm
SUB_ATT:
    s_lshl_b32 s52, s60, 10
    v_add_u32 v13, s52, v2
    v_and_b32 v5, 15, v1
    v_lshlrev_b32 v14, 4, v5
    v_lshl_add_u32 v14, v4, 8, v14
    v_add_u32 v14, s52, v14
    ds_read_b128 v[48:51], v13 offset:8192
    ds_read_b128 v[16:19], v13 offset:0
    ds_read_b128 v[44:47], v13 offset:7168
    ds_read_b128 v[40:43], v13 offset:6144
    ds_read_b128 v[36:39], v13 offset:5120
    ds_read_b128 v[32:35], v13 offset:4096
    ds_read_b128 v[28:31], v13 offset:3072
    ds_read_b128 v[24:27], v13 offset:2048
    ds_read_b128 v[20:23], v13 offset:1024
    s_cmp_eq_u32 s50, 0
    s_cselect_b32 s11, s60, 8
    s_lshl_b32 s52, s50, 3
    s_add_u32 s52, s52, s60
    s_lshl_b32 s52, s52, 5
    s_add_u32 s52, s52, s51
    s_lshl_b32 s61, s52, 2
    s_add_u32 s61, s61, 20807680
    s_lshl_b32 s62, s52, 10
    s_add_u32 s62, s62, 10485760
    s_lshr_b32 s52, s60, 2
    s_mul_i32 s52, s52, 12
    s_add_u32 s52, s52, 159748
    v_mov_b32 v11, s52
    v_mov_b32 v12, 1
    s_waitcnt lgkmcnt(8)
    v_mfma_f32_32x32x16_bf16 v[144:159], v[48:51], v[124:127], 0
    s_waitcnt lgkmcnt(7)
    v_mfma_f32_32x32x16_bf16 v[160:175], v[16:19], v[124:127], 0
    s_waitcnt lgkmcnt(6)
    v_mfma_f32_32x32x16_bf16 v[192:207], v[44:47], v[124:127], 0
    s_waitcnt lgkmcnt(0)
    v_mfma_f32_32x32x16_bf16 v[208:223], v[40:43], v[124:127], 0
    s_cmp_lg_u32 s50, 0
    s_cbranch_scc1 A_ne_124
    s_nop 5
    v_mov_b32 v160, 0xf149f2ca
    v_mov_b32 v161, 0xf149f2ca
    v_mov_b32 v162, 0xf149f2ca
    v_mov_b32 v163, 0xf149f2ca
    v_mov_b32 v164, 0xf149f2ca
    v_mov_b32 v165, 0xf149f2ca
    v_mov_b32 v166, 0xf149f2ca
    v_mov_b32 v167, 0xf149f2ca
    v_mov_b32 v168, 0xf149f2ca
    v_mov_b32 v169, 0xf149f2ca
    v_mov_b32 v170, 0xf149f2ca
    v_mov_b32 v171, 0xf149f2ca
    v_mov_b32 v172, 0xf149f2ca
    v_mov_b32 v173, 0xf149f2ca
    v_mov_b32 v174, 0xf149f2ca
    v_mov_b32 v175, 0xf149f2ca
A_ne_124:
    s_nop 5
    v_cndmask_b32 v144, v160, v144, s[64:65]
    v_cndmask_b32 v145, v161, v145, s[66:67]
    v_cndmask_b32 v146, v162, v146, s[68:69]
    v_cndmask_b32 v147, v163, v147, s[70:71]
    v_cndmask_b32 v148, v164, v148, s[72:73]
    v_cndmask_b32 v149, v165, v149, s[74:75]
    v_cndmask_b32 v150, v166, v150, s[76:77]
    v_cndmask_b32 v151, v167, v151, s[78:79]
    v_cndmask_b32 v152, v168, v152, s[80:81]
    v_cndmask_b32 v153, v169, v153, s[82:83]
    v_cndmask_b32 v154, v170, v154, s[84:85]
    v_cndmask_b32 v155, v171, v155, s[86:87]
    v_cndmask_b32 v156, v172, v156, s[88:89]
    v_cndmask_b32 v157, v173, v157, s[90:91]
    v_cndmask_b32 v158, v174, v158, s[92:93]
    v_cndmask_b32 v159, v175, v159, s[94:95]
    v_max3_f32 v10, v144, v145, v146
    v_max3_f32 v10, v10, v147, v148
    v_max3_f32 v10, v10, v149, v150
    v_max3_f32 v10, v10, v151, v152
    v_max3_f32 v10, v10, v153, v154
    v_max3_f32 v10, v10, v155, v156
    v_max3_f32 v10, v10, v157, v158
    v_max_f32 v10, v10, v159
    s_cmp_lt_u32 s11, 1
    s_cbranch_scc1 A_p1_125
    v_mfma_f32_32x32x16_bf16 v[224:239], v[36:39], v[124:127], 0
    v_max3_f32 v10, v10, v192, v193
    v_max3_f32 v10, v10, v194, v195
    v_max3_f32 v10, v10, v196, v197
    v_max3_f32 v10, v10, v198, v199
    v_max3_f32 v10, v10, v200, v201
    v_max3_f32 v10, v10, v202, v203
    v_max3_f32 v10, v10, v204, v205
    v_max3_f32 v10, v10, v206, v207
    s_cmp_lt_u32 s11, 2
    s_cbranch_scc1 A_p1_125
    v_mfma_f32_32x32x16_bf16 v[192:207], v[32:35], v[124:127], 0
    v_max3_f32 v10, v10, v208, v209
    v_max3_f32 v10, v10, v210, v211
    v_max3_f32 v10, v10, v212, v213
    v_max3_f32 v10, v10, v214, v215
    v_max3_f32 v10, v10, v216, v217
    v_max3_f32 v10, v10, v218, v219
    v_max3_f32 v10, v10, v220, v221
    v_max3_f32 v10, v10, v222, v223
    s_cmp_lt_u32 s11, 3
    s_cbranch_scc1 A_p1_125
    v_mfma_f32_32x32x16_bf16 v[208:223], v[28:31], v[124:127], 0
    v_max3_f32 v10, v10, v224, v225
    v_max3_f32 v10, v10, v226, v227
    v_max3_f32 v10, v10, v228, v229
    v_max3_f32 v10, v10, v230, v231
    v_max3_f32 v10, v10, v232, v233
    v_max3_f32 v10, v10, v234, v235
    v_max3_f32 v10, v10, v236, v237
    v_max3_f32 v10, v10, v238, v239
    s_cmp_lt_u32 s11, 4
    s_cbranch_scc1 A_p1_125
    v_mfma_f32_32x32x16_bf16 v[224:239], v[24:27], v[124:127], 0
    v_max3_f32 v10, v10, v192, v193
    v_max3_f32 v10, v10, v194, v195
    v_max3_f32 v10, v10, v196, v197
    v_max3_f32 v10, v10, v198, v199
    v_max3_f32 v10, v10, v200, v201
    v_max3_f32 v10, v10, v202, v203
    v_max3_f32 v10, v10, v204, v205
    v_max3_f32 v10, v10, v206, v207
    s_cmp_lt_u32 s11, 5
    s_cbranch_scc1 A_p1_125
    v_mfma_f32_32x32x16_bf16 v[192:207], v[20:23], v[124:127], 0
    v_max3_f32 v10, v10, v208, v209
    v_max3_f32 v10, v10, v210, v211
    v_max3_f32 v10, v10, v212, v213
    v_max3_f32 v10, v10, v214, v215
    v_max3_f32 v10, v10, v216, v217
    v_max3_f32 v10, v10, v218, v219
    v_max3_f32 v10, v10, v220, v221
    v_max3_f32 v10, v10, v222, v223
    s_cmp_lt_u32 s11, 6
    s_cbranch_scc1 A_p1_125
    v_max3_f32 v10, v10, v224, v225
    v_max3_f32 v10, v10, v226, v227
    v_max3_f32 v10, v10, v228, v229
    v_max3_f32 v10, v10, v230, v231
    v_max3_f32 v10, v10, v232, v233
    v_max3_f32 v10, v10, v234, v235
    v_max3_f32 v10, v10, v236, v237
    v_max3_f32 v10, v10, v238, v239
    s_cmp_lt_u32 s11, 7
    s_cbranch_scc1 A_p1_125
    v_max3_f32 v10, v10, v192, v193
    v_max3_f32 v10, v10, v194, v195
    v_max3_f32 v10, v10, v196, v197
    v_max3_f32 v10, v10, v198, v199
    v_max3_f32 v10, v10, v200, v201
    v_max3_f32 v10, v10, v202, v203
    v_max3_f32 v10, v10, v204, v205
    v_max3_f32 v10, v10, v206, v207
A_p1_125:
    s_cmp_lt_u32 s60, 4
    s_cbranch_scc1 A_nj_127
    s_waitcnt vmcnt(0)
    s_sub_u32 s52, s61, 512
    v_mov_b32 v5, s3
    s_add_u32 s10, s52, 65536
    s_mov_b64 exec, 1
    buffer_store_dword v5, off, s[28:31], s10
    s_cmp_lg_u32 s2, 0
    s_cbranch_scc1 gf_128
    buffer_store_dword v5, off, s[28:31], s52 sc1
gf_128:
    s_mov_b64 exec, -1
A_nj_127:
    v_mov_b32 v12, v10
    s_nop 1
    v_permlane32_swap_b32 v10, v12
    v_max_f32 v10, v10, v12
    v_sub_f32 v160, 0, v10
    v_sub_f32 v161, 0, v10
    v_mov_b64 v[162:163], v[160:161]
    v_mov_b64 v[164:165], v[160:161]
    v_mov_b64 v[166:167], v[160:161]
    v_mov_b64 v[168:169], v[160:161]
    v_mov_b64 v[170:171], v[160:161]
    v_mov_b64 v[172:173], v[160:161]
    v_mov_b64 v[174:175], v[160:161]
    s_nop 1
    v_mfma_f32_32x32x16_bf16 v[192:207], v[44:47], v[124:127], v[160:175]
    v_sub_f32 v144, v144, v10
    v_sub_f32 v145, v145, v10
    v_sub_f32 v146, v146, v10
    v_sub_f32 v147, v147, v10
    v_sub_f32 v148, v148, v10
    v_sub_f32 v149, v149, v10
    v_sub_f32 v150, v150, v10
    v_sub_f32 v151, v151, v10
    v_sub_f32 v152, v152, v10
    v_sub_f32 v153, v153, v10
    v_sub_f32 v154, v154, v10
    v_sub_f32 v155, v155, v10
    v_sub_f32 v156, v156, v10
    v_sub_f32 v157, v157, v10
    v_sub_f32 v158, v158, v10
    v_sub_f32 v159, v159, v10
    v_mfma_f32_32x32x16_bf16 v[208:223], v[40:43], v[124:127], v[160:175]
    v_exp_f32 v144, v144
    v_exp_f32 v145, v145
    v_exp_f32 v146, v146
    v_exp_f32 v147, v147
    v_exp_f32 v148, v148
    v_exp_f32 v149, v149
    v_exp_f32 v150, v150
    v_exp_f32 v151, v151
    s_cmp_ge_u32 s60, 4
    s_cbranch_scc1 A_n2_129
    s_waitcnt vmcnt(0)
    v_mov_b32 v176, 159792
    v_mov_b32 v177, 1
    s_mov_b64 exec, 1
    ds_add_u32 v176, v177
    s_mov_b64 exec, -1
    v_mov_b32 v176, 159792
    s_mov_b32 s10, 0x200000
aw_130:
    ds_read_b32 v177, v176
    s_waitcnt lgkmcnt(0)
    v_cmp_gt_u32 vcc, 4, v177
    s_nop 0
    s_cbranch_vccz aw_done_131
    s_sleep 1
    s_sub_u32 s10, s10, 1
    s_cbranch_scc0 aw_130
aw_done_131:
A_n2_129:
    v_mov_b32 v12, 1
    s_mov_b32 exec_lo, 0xffff
    s_mov_b32 exec_hi, 0xffff
    ds_read_b128 v[116:119], v14 offset:24576
    ds_read_b128 v[120:123], v14 offset:25088
    ds_read_b128 v[52:55], v14 offset:16384
    ds_read_b128 v[56:59], v14 offset:16896
    ds_read_b128 v[112:115], v14 offset:24064
    ds_read_b128 v[108:111], v14 offset:23552
    ds_read_b128 v[104:107], v14 offset:23040
    ds_read_b128 v[100:103], v14 offset:22528
    ds_read_b128 v[96:99], v14 offset:22016
    ds_read_b128 v[92:95], v14 offset:21504
    ds_read_b128 v[88:91], v14 offset:20992
    ds_read_b128 v[84:87], v14 offset:20480
    ds_read_b128 v[80:83], v14 offset:19968
    ds_read_b128 v[76:79], v14 offset:19456
    ds_read_b128 v[72:75], v14 offset:18944
    ds_read_b128 v[68:71], v14 offset:18432
    ds_read_b128 v[64:67], v14 offset:17920
    ds_read_b128 v[60:63], v14 offset:17408
    s_mov_b64 exec, 1
    ds_add_u32 v11, v12
    s_mov_b64 exec, -1
    v_exp_f32 v152, v152
    v_exp_f32 v153, v153
    v_exp_f32 v154, v154
    v_exp_f32 v155, v155
    v_exp_f32 v156, v156
    v_exp_f32 v157, v157
    v_exp_f32 v158, v158
    v_exp_f32 v159, v159
    v_cvt_pk_bf16_f32 v136, v144, v145
    v_cvt_pk_bf16_f32 v137, v146, v147
    v_cvt_pk_bf16_f32 v138, v148, v149
    v_cvt_pk_bf16_f32 v139, v150, v151
    v_cvt_pk_bf16_f32 v140, v152, v153
    v_cvt_pk_bf16_f32 v141, v154, v155
    v_cvt_pk_bf16_f32 v142, v156, v157
    v_cvt_pk_bf16_f32 v143, v158, v159
    v_and_b32 v144, v136, v240
    v_and_b32 v145, v137, v241
    v_and_b32 v146, v138, v242
    v_and_b32 v147, v139, v243
    v_and_b32 v148, v140, v244
    v_and_b32 v149, v141, v245
    v_and_b32 v150, v142, v246
    v_and_b32 v151, v143, v247
    v_xor_b32 v136, v136, v144
    v_xor_b32 v137, v137, v145
    v_xor_b32 v138, v138, v146
    v_xor_b32 v139, v139, v147
    v_xor_b32 v140, v140, v148
    v_xor_b32 v141, v141, v149
    v_xor_b32 v142, v142, v150
    v_xor_b32 v143, v143, v151
    s_waitcnt lgkmcnt(15)
    s_cmp_lt_u32 s11, 1
    s_cbranch_scc1 A_x_133
    v_exp_f32 v192, v192
    v_mfma_f32_32x32x16_bf16 v[176:191], v[116:119], v[144:147], 0
    v_exp_f32 v193, v193
    v_exp_f32 v194, v194
    v_exp_f32 v195, v195
    v_mfma_f32_32x32x16_bf16 v[176:191], v[120:123], v[148:151], v[176:191]
    v_exp_f32 v196, v196
    v_exp_f32 v197, v197
    v_exp_f32 v198, v198
    v_mfma_f32_32x32x16_bf16 v[176:191], v[52:55], v[136:139], v[176:191]
    v_exp_f32 v199, v199
    v_exp_f32 v200, v200
    v_exp_f32 v201, v201
    v_mfma_f32_32x32x16_bf16 v[176:191], v[56:59], v[140:143], v[176:191]
    v_exp_f32 v202, v202
    v_exp_f32 v203, v203
    v_exp_f32 v204, v204
    v_mfma_f32_32x32x16_bf16 v[224:239], v[36:39], v[124:127], v[160:175]
    v_exp_f32 v205, v205
    v_exp_f32 v206, v206
    v_exp_f32 v207, v207
    v_cvt_pk_bf16_f32 v192, v192, v193
    v_cvt_pk_bf16_f32 v193, v194, v195
    v_cvt_pk_bf16_f32 v194, v196, v197
    v_cvt_pk_bf16_f32 v195, v198, v199
    v_cvt_pk_bf16_f32 v196, v200, v201
    v_cvt_pk_bf16_f32 v197, v202, v203
    v_cvt_pk_bf16_f32 v198, v204, v205
    v_cvt_pk_bf16_f32 v199, v206, v207
    s_waitcnt lgkmcnt(0)
    s_cmp_lt_u32 s11, 2
    s_cbranch_scc1 A_x_134
    v_exp_f32 v208, v208
    v_mfma_f32_32x32x16_bf16 v[176:191], v[108:111], v[192:195], v[176:191]
    v_exp_f32 v209, v209
    v_exp_f32 v210, v210
    v_exp_f32 v211, v211
    v_exp_f32 v212, v212
    v_exp_f32 v213, v213
    v_mfma_f32_32x32x16_bf16 v[176:191], v[112:115], v[196:199], v[176:191]
    v_exp_f32 v214, v214
    v_exp_f32 v215, v215
    v_exp_f32 v216, v216
    v_exp_f32 v217, v217
    v_exp_f32 v218, v218
    v_mfma_f32_32x32x16_bf16 v[192:207], v[32:35], v[124:127], v[160:175]
    v_exp_f32 v219, v219
    v_exp_f32 v220, v220
    v_exp_f32 v221, v221
    v_exp_f32 v222, v222
    v_exp_f32 v223, v223
    v_cvt_pk_bf16_f32 v208, v208, v209
    v_cvt_pk_bf16_f32 v209, v210, v211
    v_cvt_pk_bf16_f32 v210, v212, v213
    v_cvt_pk_bf16_f32 v211, v214, v215
    v_cvt_pk_bf16_f32 v212, v216, v217
    v_cvt_pk_bf16_f32 v213, v218, v219
    v_cvt_pk_bf16_f32 v214, v220, v221
    v_cvt_pk_bf16_f32 v215, v222, v223
    s_cmp_lt_u32 s11, 3
    s_cbranch_scc1 A_x_135
    v_exp_f32 v224, v224
    v_mfma_f32_32x32x16_bf16 v[176:191], v[100:103], v[208:211], v[176:191]
    v_exp_f32 v225, v225
    v_exp_f32 v226, v226
    v_exp_f32 v227, v227
    v_exp_f32 v228, v228
    v_exp_f32 v229, v229
    v_mfma_f32_32x32x16_bf16 v[176:191], v[104:107], v[212:215], v[176:191]
    v_exp_f32 v230, v230
    v_exp_f32 v231, v231
    v_exp_f32 v232, v232
    v_exp_f32 v233, v233
    v_exp_f32 v234, v234
    v_mfma_f32_32x32x16_bf16 v[208:223], v[28:31], v[124:127], v[160:175]
    v_exp_f32 v235, v235
    v_exp_f32 v236, v236
    v_exp_f32 v237, v237
    v_exp_f32 v238, v238
    v_exp_f32 v239, v239
    v_cvt_pk_bf16_f32 v224, v224, v225
    v_cvt_pk_bf16_f32 v225, v226, v227
    v_cvt_pk_bf16_f32 v226, v228, v229
    v_cvt_pk_bf16_f32 v227, v230, v231
    v_cvt_pk_bf16_f32 v228, v232, v233
    v_cvt_pk_bf16_f32 v229, v234, v235
    v_cvt_pk_bf16_f32 v230, v236, v237
    v_cvt_pk_bf16_f32 v231, v238, v239
    s_cmp_lt_u32 s11, 4
    s_cbranch_scc1 A_x_136
    v_exp_f32 v192, v192
    v_mfma_f32_32x32x16_bf16 v[176:191], v[92:95], v[224:227], v[176:191]
    v_exp_f32 v193, v193
    v_exp_f32 v194, v194
    v_exp_f32 v195, v195
    v_exp_f32 v196, v196
    v_exp_f32 v197, v197
    v_mfma_f32_32x32x16_bf16 v[176:191], v[96:99], v[228:231], v[176:191]
    v_exp_f32 v198, v198
    v_exp_f32 v199, v199
    v_exp_f32 v200, v200
    v_exp_f32 v201, v201
    v_exp_f32 v202, v202
    v_mfma_f32_32x32x16_bf16 v[224:239], v[24:27], v[124:127], v[160:175]
    v_exp_f32 v203, v203
    v_exp_f32 v204, v204
    v_exp_f32 v205, v205
    v_exp_f32 v206, v206
    v_exp_f32 v207, v207
    v_cvt_pk_bf16_f32 v192, v192, v193
    v_cvt_pk_bf16_f32 v193, v194, v195
    v_cvt_pk_bf16_f32 v194, v196, v197
    v_cvt_pk_bf16_f32 v195, v198, v199
    v_cvt_pk_bf16_f32 v196, v200, v201
    v_cvt_pk_bf16_f32 v197, v202, v203
    v_cvt_pk_bf16_f32 v198, v204, v205
    v_cvt_pk_bf16_f32 v199, v206, v207
    s_cmp_lt_u32 s11, 5
    s_cbranch_scc1 A_x_137
    v_exp_f32 v208, v208
    v_mfma_f32_32x32x16_bf16 v[176:191], v[84:87], v[192:195], v[176:191]
    v_exp_f32 v209, v209
    v_exp_f32 v210, v210
    v_exp_f32 v211, v211
    v_exp_f32 v212, v212
    v_exp_f32 v213, v213
    v_mfma_f32_32x32x16_bf16 v[176:191], v[88:91], v[196:199], v[176:191]
    v_exp_f32 v214, v214
    v_exp_f32 v215, v215
    v_exp_f32 v216, v216
    v_exp_f32 v217, v217
    v_exp_f32 v218, v218
    v_mfma_f32_32x32x16_bf16 v[192:207], v[20:23], v[124:127], v[160:175]
    v_exp_f32 v219, v219
    v_exp_f32 v220, v220
    v_exp_f32 v221, v221
    v_exp_f32 v222, v222
    v_exp_f32 v223, v223
    v_cvt_pk_bf16_f32 v208, v208, v209
    v_cvt_pk_bf16_f32 v209, v210, v211
    v_cvt_pk_bf16_f32 v210, v212, v213
    v_cvt_pk_bf16_f32 v211, v214, v215
    v_cvt_pk_bf16_f32 v212, v216, v217
    v_cvt_pk_bf16_f32 v213, v218, v219
    v_cvt_pk_bf16_f32 v214, v220, v221
    v_cvt_pk_bf16_f32 v215, v222, v223
    s_cmp_lt_u32 s11, 6
    s_cbranch_scc1 A_x_138
    v_exp_f32 v224, v224
    v_mfma_f32_32x32x16_bf16 v[176:191], v[76:79], v[208:211], v[176:191]
    v_exp_f32 v225, v225
    v_exp_f32 v226, v226
    v_exp_f32 v227, v227
    v_exp_f32 v228, v228
    v_exp_f32 v229, v229
    v_mfma_f32_32x32x16_bf16 v[176:191], v[80:83], v[212:215], v[176:191]
    v_exp_f32 v230, v230
    v_exp_f32 v231, v231
    v_exp_f32 v232, v232
    v_exp_f32 v233, v233
    v_exp_f32 v234, v234
    v_exp_f32 v235, v235
    v_exp_f32 v236, v236
    v_exp_f32 v237, v237
    v_exp_f32 v238, v238
    v_exp_f32 v239, v239
    v_cvt_pk_bf16_f32 v224, v224, v225
    v_cvt_pk_bf16_f32 v225, v226, v227
    v_cvt_pk_bf16_f32 v226, v228, v229
    v_cvt_pk_bf16_f32 v227, v230, v231
    v_cvt_pk_bf16_f32 v228, v232, v233
    v_cvt_pk_bf16_f32 v229, v234, v235
    v_cvt_pk_bf16_f32 v230, v236, v237
    v_cvt_pk_bf16_f32 v231, v238, v239
    s_cmp_lt_u32 s11, 7
    s_cbranch_scc1 A_x_139
    v_exp_f32 v192, v192
    v_mfma_f32_32x32x16_bf16 v[176:191], v[68:71], v[224:227], v[176:191]
    v_exp_f32 v193, v193
    v_exp_f32 v194, v194
    v_exp_f32 v195, v195
    v_exp_f32 v196, v196
    v_exp_f32 v197, v197
    v_mfma_f32_32x32x16_bf16 v[176:191], v[72:75], v[228:231], v[176:191]
    v_exp_f32 v198, v198
    v_exp_f32 v199, v199
    v_exp_f32 v200, v200
    v_exp_f32 v201, v201
    v_exp_f32 v202, v202
    v_exp_f32 v203, v203
    v_exp_f32 v204, v204
    v_exp_f32 v205, v205
    v_exp_f32 v206, v206
    v_exp_f32 v207, v207
    v_cvt_pk_bf16_f32 v192, v192, v193
    v_cvt_pk_bf16_f32 v193, v194, v195
    v_cvt_pk_bf16_f32 v194, v196, v197
    v_cvt_pk_bf16_f32 v195, v198, v199
    v_cvt_pk_bf16_f32 v196, v200, v201
    v_cvt_pk_bf16_f32 v197, v202, v203
    v_cvt_pk_bf16_f32 v198, v204, v205
    v_cvt_pk_bf16_f32 v199, v206, v207
    v_mfma_f32_32x32x16_bf16 v[176:191], v[60:63], v[192:195], v[176:191]
    s_nop 0
    v_mfma_f32_32x32x16_bf16 v[176:191], v[64:67], v[196:199], v[176:191]
A_p2_132:
    s_waitcnt lgkmcnt(0)
    s_nop 10
    v_rcp_f32 v5, v184
    s_nop 0
    v_mul_f32 v176, v5, v176
    v_mul_f32 v177, v5, v177
    v_mul_f32 v178, v5, v178
    v_mul_f32 v179, v5, v179
    v_mul_f32 v180, v5, v180
    v_mul_f32 v181, v5, v181
    v_mul_f32 v182, v5, v182
    v_mul_f32 v183, v5, v183
    v_cvt_pk_bf16_f32 v128, v176, v177
    v_cvt_pk_bf16_f32 v129, v178, v179
    v_cvt_pk_bf16_f32 v130, v180, v181
    v_cvt_pk_bf16_f32 v131, v182, v183
    s_setpc_b64 s[0:1]
A_x_133:
    s_nop 1
    v_mfma_f32_32x32x16_bf16 v[176:191], v[116:119], v[144:147], 0
    v_mfma_f32_32x32x16_bf16 v[176:191], v[120:123], v[148:151], v[176:191]
    v_mfma_f32_32x32x16_bf16 v[176:191], v[52:55], v[136:139], v[176:191]
    v_mfma_f32_32x32x16_bf16 v[176:191], v[56:59], v[140:143], v[176:191]
    s_branch A_p2_132
A_x_134:
    s_nop 1
    v_mfma_f32_32x32x16_bf16 v[176:191], v[108:111], v[192:195], v[176:191]
    v_mfma_f32_32x32x16_bf16 v[176:191], v[112:115], v[196:199], v[176:191]
    s_branch A_p2_132
A_x_135:
    s_nop 1
    v_mfma_f32_32x32x16_bf16 v[176:191], v[100:103], v[208:211], v[176:191]
    v_mfma_f32_32x32x16_bf16 v[176:191], v[104:107], v[212:215], v[176:191]
    s_branch A_p2_132
A_x_136:
    s_nop 1
    v_mfma_f32_32x32x16_bf16 v[176:191], v[92:95], v[224:227], v[176:191]
    v_mfma_f32_32x32x16_bf16 v[176:191], v[96:99], v[228:231], v[176:191]
    s_branch A_p2_132
A_x_137:
    s_nop 1
    v_mfma_f32_32x32x16_bf16 v[176:191], v[84:87], v[192:195], v[176:191]
    v_mfma_f32_32x32x16_bf16 v[176:191], v[88:91], v[196:199], v[176:191]
    s_branch A_p2_132
A_x_138:
    s_nop 1
    v_mfma_f32_32x32x16_bf16 v[176:191], v[76:79], v[208:211], v[176:191]
    v_mfma_f32_32x32x16_bf16 v[176:191], v[80:83], v[212:215], v[176:191]
    s_branch A_p2_132
A_x_139:
    s_nop 1
    v_mfma_f32_32x32x16_bf16 v[176:191], v[68:71], v[224:227], v[176:191]
    v_mfma_f32_32x32x16_bf16 v[176:191], v[72:75], v[228:231], v[176:191]
    s_branch A_p2_132
pk_47_s:
    s_mov_b32 s10, 0x200000
pk_47_l:
    ds_read_b32 v73, v72
    s_waitcnt lgkmcnt(0)
    v_cmp_gt_u32 vcc, 4, v73
    s_nop 0
    s_cbranch_vccz pk_47
    s_sub_u32 s10, s10, 1
    s_cbranch_scc0 pk_47_l
    s_branch pk_47
pk_52_s:
    s_mov_b32 s10, 0x200000
pk_52_l:
    ds_read_b32 v73, v72
    s_waitcnt lgkmcnt(0)
    v_cmp_gt_u32 vcc, 4, v73
    s_nop 0
    s_cbranch_vccz pk_52
    s_sub_u32 s10, s10, 1
    s_cbranch_scc0 pk_52_l
    s_branch pk_52
xr_54_s:
    ds_read_b64 v[56:57], v56
    ds_read_b64 v[58:59], v58
    ds_read_b64 v[60:61], v60
    ds_read_b64 v[62:63], v62
    s_branch xr_54
xr_55_s:
    ds_read_b64 v[56:57], v56
    ds_read_b64 v[58:59], v58
    ds_read_b64 v[60:61], v60
    ds_read_b64 v[62:63], v62
    s_branch xr_55
xr_56_s:
    ds_read_b64 v[56:57], v56
    ds_read_b64 v[58:59], v58
    ds_read_b64 v[60:61], v60
    ds_read_b64 v[62:63], v62
    s_branch xr_56
xr_60_s:
    ds_read_b64 v[56:57], v56
    ds_read_b64 v[58:59], v58
    ds_read_b64 v[60:61], v60
    ds_read_b64 v[62:63], v62
    s_branch xr_60
xr_61_s:
    ds_read_b64 v[56:57], v56
    ds_read_b64 v[58:59], v58
    ds_read_b64 v[60:61], v60
    ds_read_b64 v[62:63], v62
    s_branch xr_61
xr_62_s:
    ds_read_b64 v[56:57], v56
    ds_read_b64 v[58:59], v58
    ds_read_b64 v[60:61], v60
    ds_read_b64 v[62:63], v62
    s_branch xr_62
xr_63_s:
    ds_read_b64 v[56:57], v56
    ds_read_b64 v[58:59], v58
    ds_read_b64 v[60:61], v60
    ds_read_b64 v[62:63], v62
    s_branch xr_63
xr_64_s:
    ds_read_b64 v[56:57], v56
    ds_read_b64 v[58:59], v58
    ds_read_b64 v[60:61], v60
    ds_read_b64 v[62:63], v62
    s_branch xr_64
pk_102_s:
    s_mov_b32 s10, 0x200000
pk_102_l:
    ds_read_b32 v7, v6
    s_waitcnt lgkmcnt(0)
    v_cmp_gt_u32 vcc, 4, v7
    s_nop 0
    s_cbranch_vccz pk_102
    s_sub_u32 s10, s10, 1
    s_cbranch_scc0 pk_102_l
    s_branch pk_102
pk_103_s:
    s_mov_b32 s10, 0x200000
pk_103_l:
    ds_read_b32 v7, v6
    s_waitcnt lgkmcnt(0)
    v_cmp_gt_u32 vcc, 4, v7
    s_nop 0
    s_cbranch_vccz pk_103
    s_sub_u32 s10, s10, 1
    s_cbranch_scc0 pk_103_l
    s_branch pk_103
L_code_end:
.set CODE_BYTES, L_code_end - gated_mix__sliding_block__mixer_s_mlp__prompt_kernel - 256
.section .rodata,"a"
.p2align 6
.amdhsa_kernel gated_mix__sliding_block__mixer_s_mlp__prompt_kernel
  .amdhsa_next_free_vgpr 256
  .amdhsa_next_free_sgpr 102
  .amdhsa_accum_offset 256
  .amdhsa_group_segment_fixed_size 0
  .amdhsa_kernarg_size 96
  .amdhsa_user_sgpr_count 2
  .amdhsa_user_sgpr_kernarg_segment_ptr 1
  .amdhsa_system_sgpr_workgroup_id_x 1
  .amdhsa_float_denorm_mode_32 3
  .amdhsa_float_denorm_mode_16_64 3
.end_amdhsa_kernel
```
